```python
import torch

def _softmax(x, axis=-1):
    return torch.softmax(x, dim=axis)
def _gelu(x):
    return torch.nn.functional.gelu(x, approximate="tanh")
def _silu(x):
    return torch.nn.functional.silu(x)
def _sigmoid(x):
    return torch.sigmoid(x)
def _layernorm(x, axis=-1, eps=1e-5):
    m = x.mean(dim=axis, keepdim=True)
    v = x.var(dim=axis, keepdim=True, unbiased=False)
    return (x - m) / torch.sqrt(v + eps)
def _scatter_add(tgt, idx, src, axis=0):
    return tgt.clone().index_add_(axis, idx, src)
def _segment_sum(src, seg, n):
    out = torch.zeros((n,) + src.shape[1:], dtype=src.dtype)
    return out.index_add_(0, seg, src)
def _pad(x, pw):
    flat = tuple(v for pair in reversed(pw) for v in pair)
    return torch.nn.functional.pad(x, flat)

kernel_name = 'parallel_sum__linear_kernel_hedgehog__moe_arch_mod__prompt'

def setup_inputs():

    _w = (lambda a: (lambda t: t.to(torch.bfloat16) if t.is_floating_point() else t)(torch.as_tensor(a)))
    def _A_setup():
        B, S, D, H = 1, 2048, 640, 32
        Dh = D // H
        return {
            "x": _w((lambda *s: torch.randn(*s, dtype=torch.bfloat16) * 0.05)(B, S, D)),
            "wqkv": _w((lambda *s: torch.randn(*s, dtype=torch.bfloat16) * 0.4)(D, 3 * D)),
            "w_phi": _w((lambda *s: torch.randn(*s, dtype=torch.bfloat16) * 0.4)(H, Dh, Dh) * (Dh ** -0.5)),
            "wo": _w((lambda *s: torch.randn(*s, dtype=torch.bfloat16) * 0.1)(D, D)),
        }
    _A_in = _A_setup()

    def _B_setup():
        B, S, D, F, C = 1, 2048, 640, 1728, 1
        return {
            "x": _w((lambda *s: torch.randn(*s, dtype=torch.bfloat16) * 0.05)(B, S, D)),
            "w_r": _w((lambda *s: torch.randn(*s, dtype=torch.bfloat16) * 0.05)(D)),
            "w_gate": _w((lambda *s: torch.randn(*s, dtype=torch.bfloat16) * 0.05)(D, F)),
            "w_up": _w((lambda *s: torch.randn(*s, dtype=torch.bfloat16) * 0.05)(D, F)),
            "w_down": _w((lambda *s: torch.randn(*s, dtype=torch.bfloat16) * 0.05)(F, D)),
        }
    _B_in = _B_setup()

    return {
        "A_x": _A_in["x"],
        "A_wqkv": _A_in["wqkv"],
        "A_w_phi": _A_in["w_phi"],
        "A_wo": _A_in["wo"],
        "B_x": _B_in["x"],
        "B_w_r": _B_in["w_r"],
        "B_w_gate": _B_in["w_gate"],
        "B_w_up": _B_in["w_up"],
        "B_w_down": _B_in["w_down"],
    }

def reference(A_x, A_wqkv, A_w_phi, A_wo, B_x, B_w_r, B_w_gate, B_w_up, B_w_down):
    def _A_ref(x, wqkv, w_phi, wo):
        B, S, D = x.shape
        H = 32; Dh = D // H
        qkv = (lambda x, *d: x.permute(*d))((x @ wqkv).reshape(B, S, 3, H, Dh), 2, 0, 3, 1, 4)
        q, k, v = qkv[0], qkv[1], qkv[2]
        pq = torch.einsum("bhsd,hdf->bhsf", q, w_phi)
        pk = torch.einsum("bhsd,hdf->bhsf", k, w_phi)
        phi_q = torch.concatenate([_softmax(pq, axis=-1), _softmax(-pq, axis=-1)], axis=-1)
        phi_k = torch.concatenate([_softmax(pk, axis=-1), _softmax(-pk, axis=-1)], axis=-1)
        kv = torch.einsum("bhsf,bhsd->bhfd", phi_k, v)
        z  = torch.einsum("bhsf->bhf", phi_k)
        num = torch.einsum("bhqf,bhfd->bhqd", phi_q, kv)
        den = torch.einsum("bhqf,bhf->bhq", phi_q, z)[..., None] + 1e-6
        o = num / den
        return (lambda x, *d: x.permute(*d))(o, 0, 2, 1, 3).reshape(B, S, D) @ wo

    def _B_ref(x, w_r, w_gate, w_up, w_down):
        B, S, D = x.shape
        C = 1
        r = x @ w_r
        idx = torch.argsort(-r, axis=-1)[:, :C]
        idx_e = (lambda x, n, axis: torch.repeat_interleave(x, n, dim=axis))(idx.reshape(B, C, 1), D, axis=2)
        x_sel = (lambda x, i, axis: torch.take_along_dim(x, i, dim=axis))(x, idx_e, axis=1)
        g = _silu(x_sel @ w_gate)
        u = x_sel @ w_up
        y = (g * u) @ w_down
        r_sel = _sigmoid((lambda x, i, axis: torch.take_along_dim(x, i, dim=axis))(r, idx, axis=1))
        y = y * r_sel.reshape(B, C, 1)
        b_off = (torch.arange(B) * S).reshape(B, 1)
        flat_idx = (idx + b_off).reshape(B * C)
        zero = (x * 0.0).reshape(B * S, D)
        upd = _scatter_add(zero, flat_idx, y.reshape(B * C, D), axis=0)
        return x + upd.reshape(B, S, D)

    x = A_x
    xn = _layernorm(x, axis=-1)
    return x + _A_ref(xn, A_wqkv, A_w_phi, A_wo) + _B_ref(xn, B_w_r, B_w_gate, B_w_up, B_w_down)
```

```asm
; @launch grid=(256,1,1) block=(256,1,1) lds=163840
.amdgcn_target "amdgcn-amd-amdhsa--gfx950"
.text
.globl parallel_sum__linear_kernel_hedgehog__moe_arch_mod__prompt_kernel
.p2align 8
.type parallel_sum__linear_kernel_hedgehog__moe_arch_mod__prompt_kernel,@function
parallel_sum__linear_kernel_hedgehog__moe_arch_mod__prompt_kernel:
    s_getpc_b64 s[72:73]
L_pc:
    s_load_dwordx2 s[4:5], s[0:1], 0
    s_load_dwordx2 s[8:9], s[0:1], 8
    s_load_dwordx2 s[20:21], s[0:1], 40
    s_load_dwordx2 s[12:13], s[0:1], 16
    s_cmp_ge_u32 s2, 256
    s_cbranch_scc1 L_exit
    v_and_b32 v1, 63, v0
    v_lshrrev_b32 v9, 6, v0
    s_lshr_b32 s49, s2, 3
    v_readfirstlane_b32 s3, v9
    s_and_b32 s48, s2, 7
    s_lshl_b32 s62, s49, 2
    s_add_u32 s62, s62, s3
    s_lshl_b32 s62, s62, 9
    v_lshl_add_u32 v11, v1, 7, s62
    v_cmp_gt_u32 vcc, L_code_end - L_pc, v11
    v_cmp_gt_u32 s[68:69], 4, v1
    s_nop 0
    s_and_b64 vcc, vcc, s[68:69]
    s_and_saveexec_b64 s[68:69], vcc
    s_cbranch_execz L_nopf
    global_load_dword v159, v11, s[72:73]
L_nopf:
    s_mov_b64 exec, -1
    s_load_dwordx2 s[44:45], s[0:1], 88
    s_load_dwordx2 s[40:41], s[0:1], 80
    s_load_dwordx2 s[16:17], s[0:1], 24
    s_load_dwordx2 s[24:25], s[0:1], 48
    s_load_dwordx2 s[28:29], s[0:1], 56
    s_load_dwordx2 s[32:33], s[0:1], 64
    s_load_dwordx2 s[36:37], s[0:1], 72
    s_and_b32 s62, s48, 1
    s_lshl_b32 s62, s62, 3
    s_and_b32 s63, s49, 7
    s_add_u32 s50, s62, s63
    s_lshr_b32 s62, s48, 1
    s_lshl_b32 s62, s62, 2
    s_lshr_b32 s64, s49, 3
    s_add_u32 s51, s62, s64
    s_lshl_b32 s64, s64, 1
    s_add_u32 s63, s63, s64
    s_and_b32 s63, s63, 7
    s_mul_i32 s63, s63, 10
    s_lshr_b32 s76, s63, 3
    s_lshr_b32 s64, s48, 1
    s_mul_i32 s64, s64, 3
    s_add_u32 s76, s76, s64
    s_and_b32 s64, s48, 1
    s_mul_i32 s64, s64, 0
    s_add_u32 s76, s76, s64
    s_mul_i32 s64, s76, 6554
    s_lshr_b32 s64, s64, 16
    s_mul_i32 s64, s64, 10
    s_sub_u32 s76, s76, s64
    v_lshrrev_b32 v9, 3, v1
    v_mul_u32_u24 v9, 1280, v9
    v_and_b32 v11, 7, v1
    v_lshrrev_b32 v15, 4, v1
    v_xor_b32 v11, v11, v15
    v_lshl_add_u32 v4, v11, 4, v9
    v_xor_b32 v11, 4, v11
    v_lshl_add_u32 v5, v11, 4, v9
    v_add_u32 v5, 9216, v5
    v_add_u32 v157, 18432, v4
    v_add_u32 v158, 18432, v5
    s_lshl_b32 s62, s50, 7
    s_lshl_b32 s63, s3, 5
    s_add_u32 s63, s63, s62
    s_mul_i32 s52, s63, 1280
    s_mul_i32 s53, s3, 61440
    s_mul_i32 s63, s51, 80
    s_add_u32 s53, s53, s63
    s_lshl_b32 s54, s3, 12
    s_mul_i32 s55, s3, 3072
    s_add_u32 s55, s55, 16384
    s_add_u32 s77, s52, 1280
    s_lshl_b32 s78, s76, 7
    s_add_u32 s78, s78, s52
    s_mul_i32 s79, s76, 245760
    s_add_u32 s79, s79, s53
    s_mov_b32 s6, 2621440
    s_mov_b32 s7, 0x20000
    s_mov_b32 s10, 2457600
    s_mov_b32 s11, 0x20000
    v_add_u32 v9, 0, v1
    v_mul_u32_u24 v11, 43691, v9
    v_lshrrev_b32 v11, 19, v11
    v_mul_u32_u24 v12, 12, v11
    v_sub_u32 v12, v9, v12
    v_cmp_gt_u32 s[56:57], 10, v12
    v_cmp_gt_u32 vcc, 5, v12
    v_mul_u32_u24 v11, 3840, v11
    v_lshl_add_u32 v11, v12, 4, v11
    v_mov_b32 v13, 2480
    v_add_u32 v14, 1280, v11
    v_add_u32 v11, v13, v11
    v_cndmask_b32 v6, v11, v14, vcc
    v_add_u32 v9, 64, v1
    v_mul_u32_u24 v11, 43691, v9
    v_lshrrev_b32 v11, 19, v11
    v_mul_u32_u24 v12, 12, v11
    v_sub_u32 v12, v9, v12
    v_cmp_gt_u32 s[58:59], 10, v12
    v_cmp_gt_u32 vcc, 5, v12
    v_mul_u32_u24 v11, 3840, v11
    v_lshl_add_u32 v11, v12, 4, v11
    v_mov_b32 v13, 2480
    v_add_u32 v14, 1280, v11
    v_add_u32 v11, v13, v11
    v_cndmask_b32 v7, v11, v14, vcc
    v_subrev_u32 v7, 1024, v7
    v_add_u32 v9, 128, v1
    v_mul_u32_u24 v11, 43691, v9
    v_lshrrev_b32 v11, 19, v11
    v_mul_u32_u24 v12, 12, v11
    v_sub_u32 v12, v9, v12
    v_cmp_gt_u32 s[60:61], 10, v12
    v_cmp_gt_u32 vcc, 5, v12
    v_mul_u32_u24 v11, 3840, v11
    v_lshl_add_u32 v11, v12, 4, v11
    v_mov_b32 v13, 2480
    v_add_u32 v14, 1280, v11
    v_add_u32 v11, v13, v11
    v_cndmask_b32 v8, v11, v14, vcc
    v_subrev_u32 v8, 2048, v8
    s_waitcnt lgkmcnt(0)
    s_mov_b32 s22, 1280
    s_mov_b32 s23, 0x20000
    s_mov_b32 s14, 25600
    s_mov_b32 s15, 0x20000
    v_mul_u32_u24 v10, 20, v1
    s_lshl_b32 s62, s50, 7
    s_lshl_b32 s63, s51, 3
    s_add_u32 s62, s62, s63
    s_lshl_b32 s63, s3, 1
    s_add_u32 s82, s62, s63
    s_mul_i32 s66, s82, 1280
    buffer_load_dwordx4 v[160:163], v10, s[4:7], s66 offen
    buffer_load_dword v164, v10, s[4:7], s66 offen offset:16
    buffer_load_dwordx4 v[166:169], v10, s[4:7], s66 offen offset:1280
    buffer_load_dword v170, v10, s[4:7], s66 offen offset:1296
    buffer_load_dwordx4 v[172:175], v10, s[20:23], 0 offen
    buffer_load_dword v176, v10, s[20:23], 0 offen offset:16
    v_lshlrev_b32 v11, 4, v1
    s_mul_i32 s62, s51, 1600
    s_mul_i32 s63, s3, 1664
    s_add_u32 m0, s63, 143488
    s_add_u32 s66, s63, 144512
    buffer_load_dwordx4 v11, s[12:15], s62 offen lds
    s_mov_b32 m0, s66
    s_mov_b32 exec_lo, -1
    s_mov_b32 exec_hi, 15
    s_add_u32 s62, s62, 1024
    buffer_load_dwordx4 v11, s[12:15], s62 offen lds
    s_mov_b64 exec, -1
    s_add_u32 m0, s54, 0
    s_add_u32 s63, s55, 0
    buffer_load_dwordx4 v4, s[4:7], s78 offen lds
    buffer_load_dwordx4 v5, s[4:7], s78 offen offset:1024 lds
    buffer_load_dwordx4 v157, s[4:7], s78 offen offset:2048 lds
    buffer_load_dwordx4 v158, s[4:7], s78 offen offset:3072 lds
    s_add_u32 s78, s78, 128
    s_mov_b32 m0, s63
    s_mov_b64 exec, s[56:57]
    buffer_load_dwordx4 v6, s[8:11], s79 offen lds
    s_mov_b64 exec, -1
    s_mov_b64 exec, s[58:59]
    buffer_load_dwordx4 v7, s[8:11], s79 offen offset:1024 lds
    s_mov_b64 exec, -1
    s_mov_b64 exec, s[60:61]
    buffer_load_dwordx4 v8, s[8:11], s79 offen offset:2048 lds
    s_mov_b64 exec, -1
    s_add_u32 s79, s79, 245760
    s_cmp_eq_u32 s78, s77
    s_cselect_b32 s78, s52, s78
    s_cselect_b32 s79, s53, s79
    s_mov_b32 s46, 268435456
    s_mov_b32 s47, 0x20000
    s_mov_b32 s42, 256
    s_mov_b32 s43, 0x20000
    s_lshl_b32 s62, s3, 8
    s_add_u32 s62, s62, s2
    s_cmp_lg_u32 s62, 256
    s_cbranch_scc1 L_noinit
    v_lshlrev_b32 v11, 7, v1
    v_mov_b32 v12, 0
    buffer_store_dword v12, v11, s[44:47], 0 offen sc1
L_noinit:
    s_mov_b32 s18, 819200
    s_mov_b32 s19, 0x20000
    s_mov_b32 s26, 2211840
    s_mov_b32 s27, 0x20000
    s_mov_b32 s30, 2211840
    s_mov_b32 s31, 0x20000
    s_mov_b32 s34, 2211840
    s_mov_b32 s35, 0x20000
    s_mov_b32 s38, 2621440
    s_mov_b32 s39, 0x20000
    v_and_b32 v2, 31, v1
    v_lshrrev_b32 v3, 5, v1
    v_mov_b32 v12, 0x3f80
    v_mov_b32 v13, 0
    v_mov_b32 v14, 0x3f80
    v_mov_b32 v15, 0
    v_lshrrev_b32 v9, 6, v0
    v_mul_u32_u24 v9, 28672, v9
    v_mul_u32_u24 v11, 192, v1
    v_add_u32 v9, v9, v11
    ds_write_b128 v9, v[12:15] offset:16544
    v_add_u32 v11, 114688, v11
    ds_write_b128 v11, v[12:15] offset:16544
    v_mov_b32 v16, 0
    v_mov_b32 v17, 0
    v_mov_b32 v18, 0
    v_mov_b32 v19, 0
    v_lshlrev_b32 v20, 4, v0
    v_add_u32 v20, 151232, v20
    ds_write_b128 v20, v[16:19]
    v_lshlrev_b32 v21, 3, v0
    v_add_u32 v21, 155328, v21
    ds_write_b64 v21, v[16:17]
    v_mov_b32 v84, 0x3f803f80
    v_mov_b32 v85, 0x3f803f80
    v_lshrrev_b32 v9, 1, v2
    v_and_b32 v9, 7, v9
    v_xor_b32 v9, v9, v3
    v_lshlrev_b32 v9, 4, v9
    v_lshl_add_u32 v9, v2, 7, v9
    v_add_u32 v128, s54, v9
    v_xor_b32 v129, 32, v128
    v_xor_b32 v130, 64, v128
    v_xor_b32 v131, 96, v128
    v_add_u32 v132, 86016, v128
    v_add_u32 v133, 86016, v129
    v_add_u32 v134, 86016, v130
    v_add_u32 v135, 86016, v131
    v_bfe_u32 v9, v1, 2, 2
    v_lshl_add_u32 v9, v3, 3, v9
    v_mul_u32_u24 v9, 192, v9
    v_bfe_u32 v11, v1, 4, 1
    v_and_b32 v12, 3, v1
    v_lshl_add_u32 v11, v11, 2, v12
    v_lshl_add_u32 v9, v11, 3, v9
    v_add_u32 v136, 16384, v9
    v_add_u32 v137, 73728, v9
    v_add_u32 v138, 131072, v9
    s_lshl_b32 s62, s3, 6
    v_add_u32 v72, s62, v136
    v_add_u32 v73, s62, v137
    v_add_u32 v74, s62, v138
    s_lshr_b32 s62, s48, 1
    s_lshr_b32 s63, s49, 3
    s_add_u32 s62, s62, s63
    s_lshr_b32 s63, s49, 4
    s_lshl_b32 s63, s63, 3
    s_and_b32 s64, s49, 7
    s_add_u32 s63, s63, s64
    s_mul_i32 s22, s48, 14
    s_add_u32 s22, s22, s63
    s_cmp_lt_u32 s63, 14
    s_cselect_b32 s22, s22, 255
    s_bitcmp1_b32 s62, 0
    s_cselect_b32 s22, 255, s22
    s_lshr_b32 s62, s49, 3
    s_lshl_b32 s63, s48, 2
    s_add_u32 s20, s62, s63
    s_and_b32 s21, s49, 7
    s_lshl_b32 s12, s20, 6
    s_lshl_b32 s62, s3, 4
    s_add_u32 s12, s12, s62
    s_mul_i32 s63, s21, 160
    s_mov_b32 s14, s63
    s_mul_i32 s62, s12, 1280
    s_add_u32 s85, s62, s63
    s_lshl_b32 s62, s50, 1
    s_lshr_b32 s63, s3, 1
    s_add_u32 s62, s62, s63
    s_mul_i32 s62, s62, 81920
    s_and_b32 s63, s3, 1
    s_mul_i32 s63, s63, 40960
    s_add_u32 s62, s62, s63
    s_lshr_b32 s63, s51, 2
    s_mul_i32 s63, s63, 5120
    s_add_u32 s62, s62, s63
    s_and_b32 s63, s51, 3
    s_lshl_b32 s63, s63, 8
    s_add_u32 s62, s62, s63
    s_add_u32 s84, s62, 2097152
    v_mov_b32 v9, v0
    v_cmp_lt_u32 vcc, 209, v9
    s_nop 1
    v_cndmask_b32 v10, 0, 1, vcc
    v_mul_u32_u24 v11, 210, v10
    v_sub_u32 v9, v9, v11
    v_mul_u32_u24 v11, 3121, v9
    v_lshrrev_b32 v11, 16, v11
    v_mul_u32_u24 v12, 21, v11
    v_sub_u32 v12, v9, v12
    v_lshrrev_b32 v13, 1, v11
    v_and_b32 v14, 1, v11
    v_cmp_lt_u32 vcc, 7, v11
    v_subrev_u32 v15, 4, v11
    s_nop 0
    v_cndmask_b32 v13, v13, v15, vcc
    v_cndmask_b32 v14, v14, 0, vcc
    v_lshrrev_b32 v15, 1, v13
    v_and_b32 v13, 1, v13
    v_mul_u32_u24 v15, 1024, v15
    v_lshl_add_u32 v15, v13, 9, v15
    v_lshl_add_u32 v15, v14, 3, v15
    v_mul_u32_u24 v13, 3072, v10
    v_add_u32 v15, v15, v13
    v_add_u32 v15, 151232, v15
    v_lshlrev_b32 v13, 2, v10
    v_sub_u32 v13, v12, v13
    v_add_u32 v14, 20, v13
    v_cmp_gt_i32 vcc, 0, v13
    s_nop 1
    v_cndmask_b32 v13, v13, v14, vcc
    v_subrev_u32 v14, 16, v13
    v_lshrrev_b32 v60, 3, v13
    v_and_b32 v61, 7, v13
    v_lshrrev_b32 v62, 1, v14
    v_and_b32 v63, 1, v14
    v_add_u32 v63, 8, v63
    v_cmp_lt_u32 vcc, 15, v13
    s_nop 1
    v_cndmask_b32 v60, v60, v62, vcc
    v_cndmask_b32 v61, v61, v63, vcc
    v_lshrrev_b32 v62, 2, v61
    v_lshlrev_b32 v62, 3, v62
    v_lshl_add_u32 v62, v60, 2, v62
    v_and_b32 v61, 3, v61
    v_add_u32 v62, v62, v61
    v_cmp_eq_u32 vcc, 20, v12
    s_nop 1
    v_cndmask_b32 v63, v62, 22, vcc
    v_cndmask_b32 v62, v62, 18, vcc
    v_lshl_add_u32 v62, v62, 4, v15
    v_lshl_add_u32 v63, v63, 4, v15
    v_accvgpr_write_b32 a196, v62
    v_accvgpr_write_b32 a197, v63
    s_mul_i32 s62, s3, 41
    s_add_u32 s62, s62, 256
    v_add_u32 v9, s62, v1
    v_cmp_lt_u32 vcc, 209, v9
    s_nop 1
    v_cndmask_b32 v10, 0, 1, vcc
    v_mul_u32_u24 v11, 210, v10
    v_sub_u32 v9, v9, v11
    v_mul_u32_u24 v11, 3121, v9
    v_lshrrev_b32 v11, 16, v11
    v_mul_u32_u24 v12, 21, v11
    v_sub_u32 v12, v9, v12
    v_lshrrev_b32 v13, 1, v11
    v_and_b32 v14, 1, v11
    v_cmp_lt_u32 vcc, 7, v11
    v_subrev_u32 v15, 4, v11
    s_nop 0
    v_cndmask_b32 v13, v13, v15, vcc
    v_cndmask_b32 v14, v14, 0, vcc
    v_lshrrev_b32 v15, 1, v13
    v_and_b32 v13, 1, v13
    v_mul_u32_u24 v15, 1024, v15
    v_lshl_add_u32 v15, v13, 9, v15
    v_lshl_add_u32 v15, v14, 3, v15
    v_mul_u32_u24 v13, 3072, v10
    v_add_u32 v15, v15, v13
    v_add_u32 v15, 151232, v15
    v_lshlrev_b32 v13, 2, v10
    v_sub_u32 v13, v12, v13
    v_add_u32 v14, 20, v13
    v_cmp_gt_i32 vcc, 0, v13
    s_nop 1
    v_cndmask_b32 v13, v13, v14, vcc
    v_subrev_u32 v14, 16, v13
    v_lshrrev_b32 v60, 3, v13
    v_and_b32 v61, 7, v13
    v_lshrrev_b32 v62, 1, v14
    v_and_b32 v63, 1, v14
    v_add_u32 v63, 8, v63
    v_cmp_lt_u32 vcc, 15, v13
    s_nop 1
    v_cndmask_b32 v60, v60, v62, vcc
    v_cndmask_b32 v61, v61, v63, vcc
    v_lshrrev_b32 v62, 2, v61
    v_lshlrev_b32 v62, 3, v62
    v_lshl_add_u32 v62, v60, 2, v62
    v_and_b32 v61, 3, v61
    v_add_u32 v62, v62, v61
    v_cmp_eq_u32 vcc, 20, v12
    s_nop 1
    v_cndmask_b32 v63, v62, 22, vcc
    v_cndmask_b32 v62, v62, 18, vcc
    v_lshl_add_u32 v62, v62, 4, v15
    v_lshl_add_u32 v63, v63, 4, v15
    v_accvgpr_write_b32 a198, v62
    v_accvgpr_write_b32 a199, v63
    v_add_u32 v9, 0, v1
    v_mul_u32_u24 v10, 6554, v9
    v_lshrrev_b32 v10, 16, v10
    v_mul_u32_u24 v11, 10, v10
    v_sub_u32 v11, v9, v11
    v_bfe_u32 v12, v10, 3, 1
    v_bfe_u32 v13, v10, 2, 1
    v_lshl_add_u32 v12, v12, 1, v13
    v_mul_u32_u24 v12, 40, v12
    v_lshrrev_b32 v13, 4, v10
    v_lshl_add_u32 v12, v13, 2, v12
    v_and_b32 v13, 3, v10
    v_add_u32 v12, v12, v13
    v_mul_u32_u24 v12, 1280, v12
    v_lshl_add_u32 v12, v11, 4, v12
    v_accvgpr_write_b32 a200, v12
    v_min_u32 v10, 15, v10
    v_mul_u32_u24 v12, 1280, v10
    v_lshl_add_u32 v12, v11, 4, v12
    v_accvgpr_write_b32 a205, v12
    v_mul_u32_u24 v12, 336, v10
    v_lshl_add_u32 v12, v11, 5, v12
    v_accvgpr_write_b32 a208, v12
    v_accvgpr_write_b32 a211, v10
    v_lshlrev_b32 v12, 5, v11
    v_accvgpr_write_b32 a214, v12
    v_add_u32 v9, 64, v1
    v_mul_u32_u24 v10, 6554, v9
    v_lshrrev_b32 v10, 16, v10
    v_mul_u32_u24 v11, 10, v10
    v_sub_u32 v11, v9, v11
    v_bfe_u32 v12, v10, 3, 1
    v_bfe_u32 v13, v10, 2, 1
    v_lshl_add_u32 v12, v12, 1, v13
    v_mul_u32_u24 v12, 40, v12
    v_lshrrev_b32 v13, 4, v10
    v_lshl_add_u32 v12, v13, 2, v12
    v_and_b32 v13, 3, v10
    v_add_u32 v12, v12, v13
    v_mul_u32_u24 v12, 1280, v12
    v_lshl_add_u32 v12, v11, 4, v12
    v_accvgpr_write_b32 a201, v12
    v_min_u32 v10, 15, v10
    v_mul_u32_u24 v12, 1280, v10
    v_lshl_add_u32 v12, v11, 4, v12
    v_accvgpr_write_b32 a206, v12
    v_mul_u32_u24 v12, 336, v10
    v_lshl_add_u32 v12, v11, 5, v12
    s_add_u32 m0, s54, 28672
    s_add_u32 s63, s55, 28672
    buffer_load_dwordx4 v4, s[4:7], s78 offen lds
    v_accvgpr_write_b32 a209, v12
    v_accvgpr_write_b32 a212, v10
    v_lshlrev_b32 v12, 5, v11
    v_accvgpr_write_b32 a215, v12
    v_add_u32 v9, 128, v1
    v_mul_u32_u24 v10, 6554, v9
    v_lshrrev_b32 v10, 16, v10
    v_mul_u32_u24 v11, 10, v10
    v_sub_u32 v11, v9, v11
    v_bfe_u32 v12, v10, 3, 1
    v_bfe_u32 v13, v10, 2, 1
    v_lshl_add_u32 v12, v12, 1, v13
    v_mul_u32_u24 v12, 40, v12
    v_lshrrev_b32 v13, 4, v10
    v_lshl_add_u32 v12, v13, 2, v12
    v_and_b32 v13, 3, v10
    v_add_u32 v12, v12, v13
    v_mul_u32_u24 v12, 1280, v12
    v_lshl_add_u32 v12, v11, 4, v12
    v_accvgpr_write_b32 a202, v12
    v_min_u32 v10, 15, v10
    v_mul_u32_u24 v12, 1280, v10
    v_lshl_add_u32 v12, v11, 4, v12
    v_accvgpr_write_b32 a207, v12
    v_mul_u32_u24 v12, 336, v10
    v_lshl_add_u32 v12, v11, 5, v12
    v_accvgpr_write_b32 a210, v12
    v_accvgpr_write_b32 a213, v10
    v_lshlrev_b32 v12, 5, v11
    v_accvgpr_write_b32 a216, v12
    v_add_u32 v9, 192, v1
    v_mul_u32_u24 v10, 6554, v9
    v_lshrrev_b32 v10, 16, v10
    v_mul_u32_u24 v11, 10, v10
    v_sub_u32 v11, v9, v11
    v_bfe_u32 v12, v10, 3, 1
    v_bfe_u32 v13, v10, 2, 1
    v_lshl_add_u32 v12, v12, 1, v13
    v_mul_u32_u24 v12, 40, v12
    v_lshrrev_b32 v13, 4, v10
    v_lshl_add_u32 v12, v13, 2, v12
    v_and_b32 v13, 3, v10
    v_add_u32 v12, v12, v13
    v_mul_u32_u24 v12, 1280, v12
    buffer_load_dwordx4 v5, s[4:7], s78 offen offset:1024 lds
    v_lshl_add_u32 v12, v11, 4, v12
    v_accvgpr_write_b32 a203, v12
    v_add_u32 v9, 256, v1
    v_mul_u32_u24 v10, 6554, v9
    v_lshrrev_b32 v10, 16, v10
    v_mul_u32_u24 v11, 10, v10
    v_sub_u32 v11, v9, v11
    v_bfe_u32 v12, v10, 3, 1
    v_bfe_u32 v13, v10, 2, 1
    v_lshl_add_u32 v12, v12, 1, v13
    v_mul_u32_u24 v12, 40, v12
    v_lshrrev_b32 v13, 4, v10
    v_lshl_add_u32 v12, v13, 2, v12
    v_and_b32 v13, 3, v10
    v_add_u32 v12, v12, v13
    v_mul_u32_u24 v12, 1280, v12
    v_lshl_add_u32 v12, v11, 4, v12
    v_accvgpr_write_b32 a204, v12
    v_lshrrev_b32 v9, 4, v2
    v_mul_u32_u24 v9, 20480, v9
    v_and_b32 v10, 15, v2
    v_lshl_add_u32 v9, v10, 4, v9
    v_lshl_add_u32 v10, v3, 10, v9
    v_lshl_add_u32 v11, v3, 3, v9
    v_accvgpr_write_b32 a217, v10
    v_accvgpr_write_b32 a218, v11
    v_add_u32 v9, 0, v1
    v_mul_u32_u24 v11, 52429, v9
    v_lshrrev_b32 v11, 18, v11
    v_mul_u32_u24 v12, 5, v11
    v_sub_u32 v12, v9, v12
    v_and_b32 v13, 3, v11
    v_bfe_u32 v14, v11, 2, 2
    v_and_b32 v11, 0xfffffff0, v11
    v_lshl_add_u32 v11, v13, 2, v11
    v_add_u32 v11, v11, v14
    v_mul_u32_u24 v11, 3840, v11
    v_lshl_add_u32 v152, v12, 4, v11
    v_add_u32 v9, 64, v1
    v_mul_u32_u24 v11, 52429, v9
    v_lshrrev_b32 v11, 18, v11
    v_mul_u32_u24 v12, 5, v11
    v_sub_u32 v12, v9, v12
    v_and_b32 v13, 3, v11
    v_bfe_u32 v14, v11, 2, 2
    buffer_load_dwordx4 v157, s[4:7], s78 offen offset:2048 lds
    v_and_b32 v11, 0xfffffff0, v11
    v_lshl_add_u32 v11, v13, 2, v11
    v_add_u32 v11, v11, v14
    v_mul_u32_u24 v11, 3840, v11
    v_lshl_add_u32 v153, v12, 4, v11
    v_add_u32 v9, 128, v1
    v_mul_u32_u24 v11, 52429, v9
    v_lshrrev_b32 v11, 18, v11
    v_mul_u32_u24 v12, 5, v11
    v_sub_u32 v12, v9, v12
    v_and_b32 v13, 3, v11
    v_bfe_u32 v14, v11, 2, 2
    v_and_b32 v11, 0xfffffff0, v11
    v_lshl_add_u32 v11, v13, 2, v11
    v_add_u32 v11, v11, v14
    v_mul_u32_u24 v11, 3840, v11
    v_lshl_add_u32 v154, v12, 4, v11
    v_add_u32 v9, 192, v1
    v_mul_u32_u24 v11, 52429, v9
    v_lshrrev_b32 v11, 18, v11
    v_mul_u32_u24 v12, 5, v11
    v_sub_u32 v12, v9, v12
    v_and_b32 v13, 3, v11
    v_bfe_u32 v14, v11, 2, 2
    v_and_b32 v11, 0xfffffff0, v11
    v_lshl_add_u32 v11, v13, 2, v11
    v_add_u32 v11, v11, v14
    v_mul_u32_u24 v11, 3840, v11
    v_lshl_add_u32 v155, v12, 4, v11
    v_add_u32 v9, 256, v1
    v_mul_u32_u24 v11, 52429, v9
    v_lshrrev_b32 v11, 18, v11
    v_mul_u32_u24 v12, 5, v11
    v_sub_u32 v12, v9, v12
    v_and_b32 v13, 3, v11
    v_bfe_u32 v14, v11, 2, 2
    v_and_b32 v11, 0xfffffff0, v11
    v_lshl_add_u32 v11, v13, 2, v11
    v_add_u32 v11, v11, v14
    v_mul_u32_u24 v11, 3840, v11
    v_lshl_add_u32 v156, v12, 4, v11
    s_mul_i32 s80, s3, 12800
    s_add_u32 s80, s80, 0
    s_mul_i32 s81, s3, 614400
    s_mul_i32 s62, s51, 80
    buffer_load_dwordx4 v158, s[4:7], s78 offen offset:3072 lds
    s_add_u32 s78, s78, 128
    s_add_u32 s81, s81, s62
    s_lshl_b32 s62, s3, 5
    v_add_u32 v9, s62, v2
    v_mul_u32_u24 v9, 336, v9
    v_add_u32 v9, 57344, v9
    v_lshl_add_u32 v9, v3, 3, v9
    v_accvgpr_write_b32 a192, v9
    s_lshr_b32 s62, s3, 1
    s_and_b32 s66, s3, 1
    v_bfe_u32 v9, v1, 2, 2
    v_lshlrev_b32 v9, 1, v9
    v_add_u32 v9, v9, v3
    v_lshlrev_b32 v9, 1, v9
    v_mul_u32_u24 v9, 336, v9
    v_add_u32 v9, 57344, v9
    v_bfe_u32 v11, v1, 4, 1
    v_and_b32 v12, 3, v1
    v_lshl_add_u32 v11, v11, 2, v12
    s_mul_i32 s64, s62, 12
    s_lshl_b32 s65, s66, 3
    s_add_u32 s64, s64, s65
    v_add_u32 v12, s64, v11
    v_lshl_add_u32 v13, v12, 3, v9
    v_accvgpr_write_b32 a193, v13
    s_mul_i32 s64, s62, 5
    s_add_u32 s64, s64, 24
    v_add_u32 v12, s64, v11
    s_mul_i32 s65, s62, -3
    s_add_i32 s65, s65, 37
    v_mov_b32 v13, s65
    v_cmp_eq_u32 vcc, 5, v11
    s_nop 1
    v_cndmask_b32 v12, v12, v13, vcc
    s_add_i32 s65, s65, -13
    v_add_u32 v13, s65, v11
    v_cmp_lt_u32 vcc, 5, v11
    s_nop 1
    v_cndmask_b32 v12, v12, v13, vcc
    v_lshl_add_u32 v13, v12, 3, v9
    v_accvgpr_write_b32 a194, v13
    v_mul_u32_u24 v9, 336, v3
    v_lshl_add_u32 v9, v2, 4, v9
    v_accvgpr_write_b32 a195, v9
    s_lshl_b32 s64, s51, 4
    s_add_u32 s64, s64, s50
    s_mul_i32 s64, s64, 6784
    s_add_u32 s64, s64, 65536
    s_mov_b32 m0, s63
    s_mov_b64 exec, s[56:57]
    buffer_load_dwordx4 v6, s[8:11], s79 offen lds
    s_mov_b64 exec, -1
    s_mul_i32 s65, s62, 3360
    s_add_u32 s75, s64, s65
    s_waitcnt vmcnt(12)
    v_mov_b32 v180, 0
    v_mov_b32 v181, 0
    v_mov_b32 v182, 0
    v_mov_b32 v183, 0
    v_mov_b32 v184, 0
    v_mov_b32 v185, 0
    v_mov_b32 v186, 0
    v_dot2c_f32_bf16 v180, v160, v84
    v_dot2c_f32_bf16 v181, v160, v160
    v_dot2c_f32_bf16 v182, v160, v172
    v_dot2c_f32_bf16 v183, v166, v84
    v_dot2c_f32_bf16 v184, v166, v166
    v_dot2c_f32_bf16 v185, v166, v172
    v_dot2c_f32_bf16 v186, v172, v84
    v_dot2c_f32_bf16 v180, v161, v84
    v_dot2c_f32_bf16 v181, v161, v161
    v_dot2c_f32_bf16 v182, v161, v173
    v_dot2c_f32_bf16 v183, v167, v84
    v_dot2c_f32_bf16 v184, v167, v167
    v_dot2c_f32_bf16 v185, v167, v173
    v_dot2c_f32_bf16 v186, v173, v84
    v_dot2c_f32_bf16 v180, v162, v84
    v_dot2c_f32_bf16 v181, v162, v162
    v_dot2c_f32_bf16 v182, v162, v174
    v_dot2c_f32_bf16 v183, v168, v84
    v_dot2c_f32_bf16 v184, v168, v168
    v_dot2c_f32_bf16 v185, v168, v174
    v_dot2c_f32_bf16 v186, v174, v84
    v_dot2c_f32_bf16 v180, v163, v84
    v_dot2c_f32_bf16 v181, v163, v163
    v_dot2c_f32_bf16 v182, v163, v175
    v_dot2c_f32_bf16 v183, v169, v84
    v_dot2c_f32_bf16 v184, v169, v169
    v_dot2c_f32_bf16 v185, v169, v175
    v_dot2c_f32_bf16 v186, v175, v84
    v_dot2c_f32_bf16 v180, v164, v84
    v_dot2c_f32_bf16 v181, v164, v164
    v_dot2c_f32_bf16 v182, v164, v176
    v_dot2c_f32_bf16 v183, v170, v84
    v_dot2c_f32_bf16 v184, v170, v170
    v_dot2c_f32_bf16 v185, v170, v176
    v_dot2c_f32_bf16 v186, v176, v84
    s_mov_b64 exec, s[58:59]
    buffer_load_dwordx4 v7, s[8:11], s79 offen offset:1024 lds
    s_mov_b64 exec, -1
    s_nop 2
    v_add_f32_dpp v180, v180, v180 row_shr:1 row_mask:0xf bank_mask:0xf bound_ctrl:0
    v_add_f32_dpp v181, v181, v181 row_shr:1 row_mask:0xf bank_mask:0xf bound_ctrl:0
    v_add_f32_dpp v182, v182, v182 row_shr:1 row_mask:0xf bank_mask:0xf bound_ctrl:0
    v_add_f32_dpp v183, v183, v183 row_shr:1 row_mask:0xf bank_mask:0xf bound_ctrl:0
    v_add_f32_dpp v184, v184, v184 row_shr:1 row_mask:0xf bank_mask:0xf bound_ctrl:0
    v_add_f32_dpp v185, v185, v185 row_shr:1 row_mask:0xf bank_mask:0xf bound_ctrl:0
    v_add_f32_dpp v186, v186, v186 row_shr:1 row_mask:0xf bank_mask:0xf bound_ctrl:0
    v_add_f32_dpp v180, v180, v180 row_shr:2 row_mask:0xf bank_mask:0xf bound_ctrl:0
    v_add_f32_dpp v181, v181, v181 row_shr:2 row_mask:0xf bank_mask:0xf bound_ctrl:0
    v_add_f32_dpp v182, v182, v182 row_shr:2 row_mask:0xf bank_mask:0xf bound_ctrl:0
    v_add_f32_dpp v183, v183, v183 row_shr:2 row_mask:0xf bank_mask:0xf bound_ctrl:0
    v_add_f32_dpp v184, v184, v184 row_shr:2 row_mask:0xf bank_mask:0xf bound_ctrl:0
    v_add_f32_dpp v185, v185, v185 row_shr:2 row_mask:0xf bank_mask:0xf bound_ctrl:0
    v_add_f32_dpp v186, v186, v186 row_shr:2 row_mask:0xf bank_mask:0xf bound_ctrl:0
    v_add_f32_dpp v180, v180, v180 row_shr:4 row_mask:0xf bank_mask:0xf bound_ctrl:0
    v_add_f32_dpp v181, v181, v181 row_shr:4 row_mask:0xf bank_mask:0xf bound_ctrl:0
    v_add_f32_dpp v182, v182, v182 row_shr:4 row_mask:0xf bank_mask:0xf bound_ctrl:0
    v_add_f32_dpp v183, v183, v183 row_shr:4 row_mask:0xf bank_mask:0xf bound_ctrl:0
    v_add_f32_dpp v184, v184, v184 row_shr:4 row_mask:0xf bank_mask:0xf bound_ctrl:0
    v_add_f32_dpp v185, v185, v185 row_shr:4 row_mask:0xf bank_mask:0xf bound_ctrl:0
    v_add_f32_dpp v186, v186, v186 row_shr:4 row_mask:0xf bank_mask:0xf bound_ctrl:0
    v_add_f32_dpp v180, v180, v180 row_shr:8 row_mask:0xf bank_mask:0xf bound_ctrl:0
    v_add_f32_dpp v181, v181, v181 row_shr:8 row_mask:0xf bank_mask:0xf bound_ctrl:0
    v_add_f32_dpp v182, v182, v182 row_shr:8 row_mask:0xf bank_mask:0xf bound_ctrl:0
    v_add_f32_dpp v183, v183, v183 row_shr:8 row_mask:0xf bank_mask:0xf bound_ctrl:0
    v_add_f32_dpp v184, v184, v184 row_shr:8 row_mask:0xf bank_mask:0xf bound_ctrl:0
    v_add_f32_dpp v185, v185, v185 row_shr:8 row_mask:0xf bank_mask:0xf bound_ctrl:0
    v_add_f32_dpp v186, v186, v186 row_shr:8 row_mask:0xf bank_mask:0xf bound_ctrl:0
    v_add_f32_dpp v180, v180, v180 row_bcast:15 row_mask:0xa bank_mask:0xf
    v_add_f32_dpp v181, v181, v181 row_bcast:15 row_mask:0xa bank_mask:0xf
    v_add_f32_dpp v182, v182, v182 row_bcast:15 row_mask:0xa bank_mask:0xf
    v_add_f32_dpp v183, v183, v183 row_bcast:15 row_mask:0xa bank_mask:0xf
    v_add_f32_dpp v184, v184, v184 row_bcast:15 row_mask:0xa bank_mask:0xf
    v_add_f32_dpp v185, v185, v185 row_bcast:15 row_mask:0xa bank_mask:0xf
    v_add_f32_dpp v186, v186, v186 row_bcast:15 row_mask:0xa bank_mask:0xf
    v_add_f32_dpp v180, v180, v180 row_bcast:31 row_mask:0xc bank_mask:0xf
    v_add_f32_dpp v181, v181, v181 row_bcast:31 row_mask:0xc bank_mask:0xf
    v_add_f32_dpp v182, v182, v182 row_bcast:31 row_mask:0xc bank_mask:0xf
    v_add_f32_dpp v183, v183, v183 row_bcast:31 row_mask:0xc bank_mask:0xf
    v_add_f32_dpp v184, v184, v184 row_bcast:31 row_mask:0xc bank_mask:0xf
    v_add_f32_dpp v185, v185, v185 row_bcast:31 row_mask:0xc bank_mask:0xf
    v_add_f32_dpp v186, v186, v186 row_bcast:31 row_mask:0xc bank_mask:0xf
    v_mov_b32 v198, 0x3acccccd
    v_mul_f32 v190, v180, v198
    s_mov_b64 exec, s[60:61]
    buffer_load_dwordx4 v8, s[8:11], s79 offen offset:2048 lds
    s_mov_b64 exec, -1
    s_add_u32 s79, s79, 245760
    s_cmp_eq_u32 s78, s77
    s_cselect_b32 s78, s52, s78
    s_cselect_b32 s79, s53, s79
    v_mul_f32 v191, v181, v198
    v_fma_f32 v191, -v190, v190, v191
    v_max_f32 v191, 0, v191
    v_cvt_pk_bf16_f32 v191, v191, v191
    v_lshlrev_b32 v191, 16, v191
    v_add_f32 v191, 0x3727c5ac, v191
    v_cvt_pk_bf16_f32 v191, v191, v191
    v_lshlrev_b32 v191, 16, v191
    v_sqrt_f32 v191, v191
    s_nop 0
    v_cvt_pk_bf16_f32 v191, v191, v191
    v_lshlrev_b32 v191, 16, v191
    v_cvt_pk_bf16_f32 v190, v190, v190
    v_lshlrev_b32 v190, 16, v190
    v_rcp_f32 v191, v191
    v_fma_f32 v192, -v190, v186, v182
    v_mul_f32 v192, v192, v191
    v_mul_f32 v193, v183, v198
    v_mul_f32 v194, v184, v198
    v_fma_f32 v194, -v193, v193, v194
    v_max_f32 v194, 0, v194
    v_cvt_pk_bf16_f32 v194, v194, v194
    v_lshlrev_b32 v194, 16, v194
    v_add_f32 v194, 0x3727c5ac, v194
    v_cvt_pk_bf16_f32 v194, v194, v194
    v_lshlrev_b32 v194, 16, v194
    v_sqrt_f32 v194, v194
    s_nop 0
    v_cvt_pk_bf16_f32 v194, v194, v194
    v_lshlrev_b32 v194, 16, v194
    v_cvt_pk_bf16_f32 v193, v193, v193
    v_lshlrev_b32 v193, 16, v193
    v_rcp_f32 v194, v194
    v_fma_f32 v195, -v193, v186, v185
    v_mul_f32 v195, v195, v194
    v_mov_b32 v197, s82
    v_add_u32 v199, 1, v197
    v_cmp_gt_f32 vcc, v195, v192
    s_nop 1
    v_cndmask_b32 v196, v192, v195, vcc
    v_cndmask_b32 v197, v197, v199, vcc
    s_lshl_b32 s62, s3, 3
    s_add_u32 s62, s62, 151168
    v_mov_b32 v9, s62
    s_mov_b32 exec_lo, 0
    s_brev_b32 exec_hi, 1
    ds_write_b64 v9, v[196:197]
    s_mov_b64 exec, -1
    s_add_u32 m0, s54, 57344
    s_add_u32 s63, s55, 57344
    buffer_load_dwordx4 v4, s[4:7], s78 offen lds
    v_lshrrev_b32 v9, 3, v2
    v_and_b32 v11, 3, v2
    v_lshl_add_u32 v9, v9, 2, v11
    v_min_u32 v9, 9, v9
    v_bfe_u32 v11, v2, 2, 1
    v_mad_u32_u24 v9, v11, 10, v9
    v_lshlrev_b32 v9, 1, v9
    s_mul_i32 s62, s3, 1664
    buffer_load_dwordx4 v5, s[4:7], s78 offen offset:1024 lds
    s_add_u32 s62, s62, 143488
    v_add_u32 v9, s62, v9
    v_mul_u32_u24 v11, 160, v3
    v_add_u32 v11, v11, v9
    ds_read_u16 v200, v11 offset:0
    ds_read_u16 v201, v11 offset:40
    ds_read_u16 v202, v11 offset:80
    ds_read_u16 v203, v11 offset:120
    buffer_load_dwordx4 v157, s[4:7], s78 offen offset:2048 lds
    ds_read_u16 v204, v11 offset:320
    ds_read_u16 v205, v11 offset:360
    ds_read_u16 v206, v11 offset:400
    ds_read_u16 v207, v11 offset:440
    ds_read_u16 v208, v11 offset:640
    ds_read_u16 v209, v11 offset:680
    ds_read_u16 v210, v11 offset:720
    ds_read_u16 v211, v11 offset:760
    buffer_load_dwordx4 v158, s[4:7], s78 offen offset:3072 lds
    s_add_u32 s78, s78, 128
    s_waitcnt lgkmcnt(0)
    v_lshl_or_b32 v140, v201, 16, v200
    v_lshl_or_b32 v141, v203, 16, v202
    v_lshl_or_b32 v142, v205, 16, v204
    v_lshl_or_b32 v143, v207, 16, v206
    v_lshl_or_b32 v144, v209, 16, v208
    v_lshl_or_b32 v145, v211, 16, v210
    ds_read_u16 v200, v9 offset:800
    ds_read_u16 v201, v9 offset:840
    s_mov_b32 m0, s63
    s_mov_b64 exec, s[56:57]
    buffer_load_dwordx4 v6, s[8:11], s79 offen lds
    s_mov_b64 exec, -1
    ds_read_u16 v202, v9 offset:880
    ds_read_u16 v203, v9 offset:920
    s_waitcnt lgkmcnt(0)
    v_lshl_or_b32 v146, v201, 16, v200
    v_lshl_or_b32 v147, v203, 16, v202
    ds_read_u16 v200, v11 offset:960
    ds_read_u16 v201, v11 offset:1000
    ds_read_u16 v202, v11 offset:1040
    s_mov_b64 exec, s[58:59]
    buffer_load_dwordx4 v7, s[8:11], s79 offen offset:1024 lds
    s_mov_b64 exec, -1
    ds_read_u16 v203, v11 offset:1080
    ds_read_u16 v204, v11 offset:1280
    ds_read_u16 v205, v11 offset:1320
    ds_read_u16 v206, v11 offset:1360
    ds_read_u16 v207, v11 offset:1400
    s_waitcnt lgkmcnt(0)
    v_lshl_or_b32 v148, v201, 16, v200
    v_lshl_or_b32 v149, v203, 16, v202
    s_mov_b64 exec, s[60:61]
    buffer_load_dwordx4 v8, s[8:11], s79 offen offset:2048 lds
    s_mov_b64 exec, -1
    s_add_u32 s79, s79, 245760
    s_cmp_eq_u32 s78, s77
    s_cselect_b32 s78, s52, s78
    s_cselect_b32 s79, s53, s79
    v_lshl_or_b32 v150, v205, 16, v204
    v_lshl_or_b32 v151, v207, 16, v206
    s_mov_b32 s68, 0
    s_mov_b32 s69, -1
    s_waitcnt lgkmcnt(0)
    v_cndmask_b32 v144, v144, 0, s[68:69]
    v_cndmask_b32 v145, v145, 0, s[68:69]
    v_cndmask_b32 v146, 0, v146, s[68:69]
    v_cndmask_b32 v147, 0, v147, s[68:69]
    s_waitcnt vmcnt(14)
    s_waitcnt lgkmcnt(0)
    s_barrier
    ds_read_b128 a[0:3], v128 offset:0
    ds_read_b64_tr_b16 v[92:93], v136 offset:0
    ds_read_b64_tr_b16 v[94:95], v136 offset:768
    ds_read_b64_tr_b16 v[96:97], v136 offset:64
    ds_read_b64_tr_b16 v[98:99], v136 offset:832
    ds_read_b64_tr_b16 v[100:101], v136 offset:128
    ds_read_b64_tr_b16 v[102:103], v136 offset:896
    ds_read_b64_tr_b16 v[160:161], v72 offset:0
    ds_read_b64_tr_b16 v[162:163], v72 offset:768
    s_waitcnt lgkmcnt(6)
    ds_read_b128 a[4:7], v129 offset:0
    ds_read_b64_tr_b16 v[104:105], v136 offset:3072
    ds_read_b64_tr_b16 v[106:107], v136 offset:3840
    ds_read_b64_tr_b16 v[108:109], v136 offset:3136
    ds_read_b64_tr_b16 v[110:111], v136 offset:3904
    ds_read_b64_tr_b16 v[112:113], v136 offset:3200
    ds_read_b64_tr_b16 v[114:115], v136 offset:3968
    ds_read_b64_tr_b16 v[164:165], v72 offset:3072
    ds_read_b64_tr_b16 v[166:167], v72 offset:3840
    s_cmp_lg_u32 s3, 0
    s_cbranch_scc1 L_nopub
    v_mov_b32 v9, 151168
    ds_read_b128 v[172:175], v9
    ds_read_b128 v[176:179], v9 offset:16
    s_lshl_b32 s62, s2, 3
    s_add_u32 s62, s62, 5275648
    v_mov_b32 v11, s62
    s_waitcnt lgkmcnt(0)
    v_cmp_gt_f32 vcc, v174, v172
    s_nop 1
    v_cndmask_b32 v172, v172, v174, vcc
    v_cndmask_b32 v173, v173, v175, vcc
    v_cmp_gt_f32 vcc, v176, v172
    s_nop 1
    v_cndmask_b32 v172, v172, v176, vcc
    v_cndmask_b32 v173, v173, v177, vcc
    v_cmp_gt_f32 vcc, v178, v172
    s_nop 1
    v_cndmask_b32 v172, v172, v178, vcc
    v_cndmask_b32 v173, v173, v179, vcc
    s_mov_b64 exec, 1
    buffer_store_dwordx2 v[172:173], v11, s[44:47], 0 offen sc1
    s_mov_b64 exec, -1
L_nopub:
    s_waitcnt lgkmcnt(6)
    v_mfma_f32_32x32x16_bf16 v[16:31], v[92:95], a[0:3], 0
    ds_read_b128 a[8:11], v130 offset:0
    ds_read_b64_tr_b16 v[116:117], v136 offset:6144
    ds_read_b64_tr_b16 v[118:119], v136 offset:6912
    s_add_u32 m0, s54, 86016
    s_add_u32 s63, s55, 86016
    buffer_load_dwordx4 v4, s[4:7], s78 offen lds
    v_mfma_f32_32x32x16_bf16 v[32:47], v[96:99], a[0:3], 0
    ds_read_b64_tr_b16 v[120:121], v136 offset:6208
    ds_read_b64_tr_b16 v[122:123], v136 offset:6976
    ds_read_b64_tr_b16 v[124:125], v136 offset:6272
    v_mfma_f32_32x32x16_bf16 v[48:63], v[100:103], a[0:3], 0
    ds_read_b64_tr_b16 v[126:127], v136 offset:7040
    ds_read_b64_tr_b16 v[168:169], v72 offset:6144
    ds_read_b64_tr_b16 v[170:171], v72 offset:6912
    buffer_load_dwordx4 v5, s[4:7], s78 offen offset:1024 lds
    s_waitcnt lgkmcnt(6)
    v_mfma_f32_4x4x4_16b_bf16 v[64:67], a[0:1], a[0:1], 0
    v_mfma_f32_4x4x4_16b_bf16 v[68:71], a[2:3], a[2:3], 0
    v_mfma_f32_4x4x4_16b_bf16 v[76:79], v[160:161], v[84:85], 0
    v_mfma_f32_4x4x4_16b_bf16 v[80:83], v[162:163], v[84:85], 0
    v_mfma_f32_4x4x4_16b_bf16 v[64:67], a[4:5], a[4:5], v[64:67]
    v_mfma_f32_4x4x4_16b_bf16 v[68:71], a[6:7], a[6:7], v[68:71]
    v_mfma_f32_4x4x4_16b_bf16 v[76:79], v[164:165], v[84:85], v[76:79]
    v_mfma_f32_4x4x4_16b_bf16 v[80:83], v[166:167], v[84:85], v[80:83]
    v_mfma_f32_32x32x16_bf16 v[16:31], v[104:107], a[4:7], v[16:31]
    ds_read_b128 a[12:15], v131 offset:0
    ds_read_b64_tr_b16 v[92:93], v136 offset:9216
    ds_read_b64_tr_b16 v[94:95], v136 offset:9984
    buffer_load_dwordx4 v157, s[4:7], s78 offen offset:2048 lds
    v_mfma_f32_32x32x16_bf16 v[32:47], v[108:111], a[4:7], v[32:47]
    ds_read_b64_tr_b16 v[96:97], v136 offset:9280
    ds_read_b64_tr_b16 v[98:99], v136 offset:10048
    ds_read_b64_tr_b16 v[100:101], v136 offset:9344
    v_mfma_f32_32x32x16_bf16 v[48:63], v[112:115], a[4:7], v[48:63]
    ds_read_b64_tr_b16 v[102:103], v136 offset:10112
    ds_read_b64_tr_b16 v[160:161], v72 offset:9216
    ds_read_b64_tr_b16 v[162:163], v72 offset:9984
    buffer_load_dwordx4 v158, s[4:7], s78 offen offset:3072 lds
    s_add_u32 s78, s78, 128
    s_waitcnt lgkmcnt(6)
    s_waitcnt vmcnt(11)
    s_barrier
    s_cmp_lg_u32 s2, 0
    s_cbranch_scc1 L_noready
    s_cmp_lg_u32 s3, 1
    s_cbranch_scc1 L_noready
    s_memrealtime s[64:65]
    v_mov_b32 v11, 240
    s_waitcnt lgkmcnt(0)
    s_mul_i32 s64, s64, 0x9e3779b1
    s_or_b32 s64, s64, 1
    v_mov_b32 v12, s64
    s_mov_b64 exec, 1
    buffer_store_dword v12, v11, s[40:43], 0 offen sc1
    s_mov_b64 exec, -1
L_noready:
    v_mfma_f32_32x32x16_bf16 v[16:31], v[116:119], a[8:11], v[16:31]
    ds_read_b128 a[16:19], v128 offset:28672
    ds_read_b64_tr_b16 v[104:105], v136 offset:28672
    ds_read_b64_tr_b16 v[106:107], v136 offset:29440
    s_mov_b32 m0, s63
    s_mov_b64 exec, s[56:57]
    buffer_load_dwordx4 v6, s[8:11], s79 offen lds
    s_mov_b64 exec, -1
    v_mfma_f32_32x32x16_bf16 v[32:47], v[120:123], a[8:11], v[32:47]
    ds_read_b64_tr_b16 v[108:109], v136 offset:28736
    ds_read_b64_tr_b16 v[110:111], v136 offset:29504
    ds_read_b64_tr_b16 v[112:113], v136 offset:28800
    v_mfma_f32_32x32x16_bf16 v[48:63], v[124:127], a[8:11], v[48:63]
    ds_read_b64_tr_b16 v[114:115], v136 offset:29568
    ds_read_b64_tr_b16 v[164:165], v72 offset:28672
    ds_read_b64_tr_b16 v[166:167], v72 offset:29440
    s_mov_b64 exec, s[58:59]
    buffer_load_dwordx4 v7, s[8:11], s79 offen offset:1024 lds
    s_mov_b64 exec, -1
    s_waitcnt lgkmcnt(6)
    v_mfma_f32_4x4x4_16b_bf16 v[64:67], a[8:9], a[8:9], v[64:67]
    v_mfma_f32_4x4x4_16b_bf16 v[68:71], a[10:11], a[10:11], v[68:71]
    v_mfma_f32_4x4x4_16b_bf16 v[76:79], v[168:169], v[84:85], v[76:79]
    v_mfma_f32_4x4x4_16b_bf16 v[80:83], v[170:171], v[84:85], v[80:83]
    v_mfma_f32_4x4x4_16b_bf16 v[64:67], a[12:13], a[12:13], v[64:67]
    v_mfma_f32_4x4x4_16b_bf16 v[68:71], a[14:15], a[14:15], v[68:71]
    v_mfma_f32_4x4x4_16b_bf16 v[76:79], v[160:161], v[84:85], v[76:79]
    v_mfma_f32_4x4x4_16b_bf16 v[80:83], v[162:163], v[84:85], v[80:83]
    v_mfma_f32_32x32x16_bf16 v[16:31], v[92:95], a[12:15], v[16:31]
    ds_read_b128 a[20:23], v129 offset:28672
    ds_read_b64_tr_b16 v[116:117], v136 offset:31744
    ds_read_b64_tr_b16 v[118:119], v136 offset:32512
    s_mov_b64 exec, s[60:61]
    buffer_load_dwordx4 v8, s[8:11], s79 offen offset:2048 lds
    s_mov_b64 exec, -1
    s_add_u32 s79, s79, 245760
    s_cmp_eq_u32 s78, s77
    s_cselect_b32 s78, s52, s78
    s_cselect_b32 s79, s53, s79
    v_mfma_f32_32x32x16_bf16 v[32:47], v[96:99], a[12:15], v[32:47]
    ds_read_b64_tr_b16 v[120:121], v136 offset:31808
    ds_read_b64_tr_b16 v[122:123], v136 offset:32576
    ds_read_b64_tr_b16 v[124:125], v136 offset:31872
    v_mfma_f32_32x32x16_bf16 v[48:63], v[100:103], a[12:15], v[48:63]
    ds_read_b64_tr_b16 v[126:127], v136 offset:32640
    ds_read_b64_tr_b16 v[168:169], v72 offset:31744
    ds_read_b64_tr_b16 v[170:171], v72 offset:32512
    s_waitcnt lgkmcnt(6)
    v_mfma_f32_32x32x16_bf16 v[16:31], v[104:107], a[16:19], v[16:31]
    ds_read_b128 a[24:27], v130 offset:28672
    ds_read_b64_tr_b16 v[92:93], v136 offset:34816
    ds_read_b64_tr_b16 v[94:95], v136 offset:35584
    s_add_u32 m0, s54, 114688
    s_add_u32 s63, s55, 114688
    buffer_load_dwordx4 v4, s[4:7], s78 offen lds
    v_mfma_f32_32x32x16_bf16 v[32:47], v[108:111], a[16:19], v[32:47]
    ds_read_b64_tr_b16 v[96:97], v136 offset:34880
    ds_read_b64_tr_b16 v[98:99], v136 offset:35648
    ds_read_b64_tr_b16 v[100:101], v136 offset:34944
    v_mfma_f32_32x32x16_bf16 v[48:63], v[112:115], a[16:19], v[48:63]
    ds_read_b64_tr_b16 v[102:103], v136 offset:35712
    ds_read_b64_tr_b16 v[160:161], v72 offset:34816
    ds_read_b64_tr_b16 v[162:163], v72 offset:35584
    buffer_load_dwordx4 v5, s[4:7], s78 offen offset:1024 lds
    s_waitcnt lgkmcnt(6)
    v_mfma_f32_4x4x4_16b_bf16 v[64:67], a[16:17], a[16:17], v[64:67]
    v_mfma_f32_4x4x4_16b_bf16 v[68:71], a[18:19], a[18:19], v[68:71]
    v_mfma_f32_4x4x4_16b_bf16 v[76:79], v[164:165], v[84:85], v[76:79]
    v_mfma_f32_4x4x4_16b_bf16 v[80:83], v[166:167], v[84:85], v[80:83]
    v_mfma_f32_4x4x4_16b_bf16 v[64:67], a[20:21], a[20:21], v[64:67]
    v_mfma_f32_4x4x4_16b_bf16 v[68:71], a[22:23], a[22:23], v[68:71]
    v_mfma_f32_4x4x4_16b_bf16 v[76:79], v[168:169], v[84:85], v[76:79]
    v_mfma_f32_4x4x4_16b_bf16 v[80:83], v[170:171], v[84:85], v[80:83]
    v_mfma_f32_32x32x16_bf16 v[16:31], v[116:119], a[20:23], v[16:31]
    ds_read_b128 a[28:31], v131 offset:28672
    ds_read_b64_tr_b16 v[104:105], v136 offset:37888
    ds_read_b64_tr_b16 v[106:107], v136 offset:38656
    buffer_load_dwordx4 v157, s[4:7], s78 offen offset:2048 lds
    v_mfma_f32_32x32x16_bf16 v[32:47], v[120:123], a[20:23], v[32:47]
    ds_read_b64_tr_b16 v[108:109], v136 offset:37952
    ds_read_b64_tr_b16 v[110:111], v136 offset:38720
    ds_read_b64_tr_b16 v[112:113], v136 offset:38016
    v_mfma_f32_32x32x16_bf16 v[48:63], v[124:127], a[20:23], v[48:63]
    ds_read_b64_tr_b16 v[114:115], v136 offset:38784
    ds_read_b64_tr_b16 v[164:165], v72 offset:37888
    ds_read_b64_tr_b16 v[166:167], v72 offset:38656
    buffer_load_dwordx4 v158, s[4:7], s78 offen offset:3072 lds
    s_add_u32 s78, s78, 128
    s_waitcnt lgkmcnt(6)
    s_waitcnt vmcnt(11)
    s_barrier
    v_mfma_f32_32x32x16_bf16 v[16:31], v[92:95], a[24:27], v[16:31]
    ds_read_b128 a[32:35], v128 offset:57344
    ds_read_b64_tr_b16 v[116:117], v137 offset:0
    ds_read_b64_tr_b16 v[118:119], v137 offset:768
    s_mov_b32 m0, s63
    s_mov_b64 exec, s[56:57]
    buffer_load_dwordx4 v6, s[8:11], s79 offen lds
    s_mov_b64 exec, -1
    v_mfma_f32_32x32x16_bf16 v[32:47], v[96:99], a[24:27], v[32:47]
    ds_read_b64_tr_b16 v[120:121], v137 offset:64
    ds_read_b64_tr_b16 v[122:123], v137 offset:832
    ds_read_b64_tr_b16 v[124:125], v137 offset:128
    v_mfma_f32_32x32x16_bf16 v[48:63], v[100:103], a[24:27], v[48:63]
    ds_read_b64_tr_b16 v[126:127], v137 offset:896
    ds_read_b64_tr_b16 v[168:169], v73 offset:0
    ds_read_b64_tr_b16 v[170:171], v73 offset:768
    s_mov_b64 exec, s[58:59]
    buffer_load_dwordx4 v7, s[8:11], s79 offen offset:1024 lds
    s_mov_b64 exec, -1
    s_waitcnt lgkmcnt(6)
    v_mfma_f32_4x4x4_16b_bf16 v[64:67], a[24:25], a[24:25], v[64:67]
    v_mfma_f32_4x4x4_16b_bf16 v[68:71], a[26:27], a[26:27], v[68:71]
    v_mfma_f32_4x4x4_16b_bf16 v[76:79], v[160:161], v[84:85], v[76:79]
    v_mfma_f32_4x4x4_16b_bf16 v[80:83], v[162:163], v[84:85], v[80:83]
    v_mfma_f32_4x4x4_16b_bf16 v[64:67], a[28:29], a[28:29], v[64:67]
    v_mfma_f32_4x4x4_16b_bf16 v[68:71], a[30:31], a[30:31], v[68:71]
    v_mfma_f32_4x4x4_16b_bf16 v[76:79], v[164:165], v[84:85], v[76:79]
    v_mfma_f32_4x4x4_16b_bf16 v[80:83], v[166:167], v[84:85], v[80:83]
    v_mfma_f32_32x32x16_bf16 v[16:31], v[104:107], a[28:31], v[16:31]
    ds_read_b128 a[36:39], v129 offset:57344
    ds_read_b64_tr_b16 v[92:93], v137 offset:3072
    ds_read_b64_tr_b16 v[94:95], v137 offset:3840
    s_mov_b64 exec, s[60:61]
    buffer_load_dwordx4 v8, s[8:11], s79 offen offset:2048 lds
    s_mov_b64 exec, -1
    s_add_u32 s79, s79, 245760
    s_cmp_eq_u32 s78, s77
    s_cselect_b32 s78, s52, s78
    s_cselect_b32 s79, s53, s79
    v_mfma_f32_32x32x16_bf16 v[32:47], v[108:111], a[28:31], v[32:47]
    ds_read_b64_tr_b16 v[96:97], v137 offset:3136
    ds_read_b64_tr_b16 v[98:99], v137 offset:3904
    ds_read_b64_tr_b16 v[100:101], v137 offset:3200
    v_mfma_f32_32x32x16_bf16 v[48:63], v[112:115], a[28:31], v[48:63]
    ds_read_b64_tr_b16 v[102:103], v137 offset:3968
    ds_read_b64_tr_b16 v[160:161], v73 offset:3072
    ds_read_b64_tr_b16 v[162:163], v73 offset:3840
    s_waitcnt lgkmcnt(6)
    v_mfma_f32_32x32x16_bf16 v[16:31], v[116:119], a[32:35], v[16:31]
    ds_read_b128 a[40:43], v130 offset:57344
    ds_read_b64_tr_b16 v[104:105], v137 offset:6144
    ds_read_b64_tr_b16 v[106:107], v137 offset:6912
    s_add_u32 m0, s54, 0
    s_add_u32 s63, s55, 0
    buffer_load_dwordx4 v4, s[4:7], s78 offen lds
    v_mfma_f32_32x32x16_bf16 v[32:47], v[120:123], a[32:35], v[32:47]
    ds_read_b64_tr_b16 v[108:109], v137 offset:6208
    ds_read_b64_tr_b16 v[110:111], v137 offset:6976
    ds_read_b64_tr_b16 v[112:113], v137 offset:6272
    v_mfma_f32_32x32x16_bf16 v[48:63], v[124:127], a[32:35], v[48:63]
    ds_read_b64_tr_b16 v[114:115], v137 offset:7040
    ds_read_b64_tr_b16 v[164:165], v73 offset:6144
    ds_read_b64_tr_b16 v[166:167], v73 offset:6912
    buffer_load_dwordx4 v5, s[4:7], s78 offen offset:1024 lds
    s_waitcnt lgkmcnt(6)
    v_mfma_f32_4x4x4_16b_bf16 v[64:67], a[32:33], a[32:33], v[64:67]
    v_mfma_f32_4x4x4_16b_bf16 v[68:71], a[34:35], a[34:35], v[68:71]
    v_mfma_f32_4x4x4_16b_bf16 v[76:79], v[168:169], v[84:85], v[76:79]
    v_mfma_f32_4x4x4_16b_bf16 v[80:83], v[170:171], v[84:85], v[80:83]
    v_mfma_f32_4x4x4_16b_bf16 v[64:67], a[36:37], a[36:37], v[64:67]
    v_mfma_f32_4x4x4_16b_bf16 v[68:71], a[38:39], a[38:39], v[68:71]
    v_mfma_f32_4x4x4_16b_bf16 v[76:79], v[160:161], v[84:85], v[76:79]
    v_mfma_f32_4x4x4_16b_bf16 v[80:83], v[162:163], v[84:85], v[80:83]
    v_mfma_f32_32x32x16_bf16 v[16:31], v[92:95], a[36:39], v[16:31]
    ds_read_b128 a[44:47], v131 offset:57344
    ds_read_b64_tr_b16 v[116:117], v137 offset:9216
    ds_read_b64_tr_b16 v[118:119], v137 offset:9984
    buffer_load_dwordx4 v157, s[4:7], s78 offen offset:2048 lds
    v_mfma_f32_32x32x16_bf16 v[32:47], v[96:99], a[36:39], v[32:47]
    ds_read_b64_tr_b16 v[120:121], v137 offset:9280
    ds_read_b64_tr_b16 v[122:123], v137 offset:10048
    ds_read_b64_tr_b16 v[124:125], v137 offset:9344
    v_mfma_f32_32x32x16_bf16 v[48:63], v[100:103], a[36:39], v[48:63]
    ds_read_b64_tr_b16 v[126:127], v137 offset:10112
    ds_read_b64_tr_b16 v[168:169], v73 offset:9216
    ds_read_b64_tr_b16 v[170:171], v73 offset:9984
    buffer_load_dwordx4 v158, s[4:7], s78 offen offset:3072 lds
    s_add_u32 s78, s78, 128
    s_waitcnt lgkmcnt(6)
    s_waitcnt vmcnt(11)
    s_barrier
    s_cmp_lg_u32 s3, 0
    s_cbranch_scc1 L_noatom
    s_and_b32 s62, s2, 3
    s_lshl_b32 s62, s62, 6
    v_mov_b32 v11, s62
    v_mov_b32 v12, 1
    s_mov_b64 exec, 1
    buffer_atomic_add v12, v11, s[40:43], 0 offen sc1
    s_mov_b64 exec, -1
L_noatom:
    v_mfma_f32_32x32x16_bf16 v[16:31], v[104:107], a[40:43], v[16:31]
    ds_read_b128 a[48:51], v132 offset:0
    ds_read_b64_tr_b16 v[92:93], v137 offset:28672
    ds_read_b64_tr_b16 v[94:95], v137 offset:29440
    s_mov_b32 m0, s63
    s_mov_b64 exec, s[56:57]
    buffer_load_dwordx4 v6, s[8:11], s79 offen lds
    s_mov_b64 exec, -1
    v_mfma_f32_32x32x16_bf16 v[32:47], v[108:111], a[40:43], v[32:47]
    ds_read_b64_tr_b16 v[96:97], v137 offset:28736
    ds_read_b64_tr_b16 v[98:99], v137 offset:29504
    ds_read_b64_tr_b16 v[100:101], v137 offset:28800
    v_mfma_f32_32x32x16_bf16 v[48:63], v[112:115], a[40:43], v[48:63]
    ds_read_b64_tr_b16 v[102:103], v137 offset:29568
    ds_read_b64_tr_b16 v[160:161], v73 offset:28672
    ds_read_b64_tr_b16 v[162:163], v73 offset:29440
    s_mov_b64 exec, s[58:59]
    buffer_load_dwordx4 v7, s[8:11], s79 offen offset:1024 lds
    s_mov_b64 exec, -1
    s_waitcnt lgkmcnt(6)
    v_mfma_f32_4x4x4_16b_bf16 v[64:67], a[40:41], a[40:41], v[64:67]
    v_mfma_f32_4x4x4_16b_bf16 v[68:71], a[42:43], a[42:43], v[68:71]
    v_mfma_f32_4x4x4_16b_bf16 v[76:79], v[164:165], v[84:85], v[76:79]
    v_mfma_f32_4x4x4_16b_bf16 v[80:83], v[166:167], v[84:85], v[80:83]
    v_mfma_f32_4x4x4_16b_bf16 v[64:67], a[44:45], a[44:45], v[64:67]
    v_mfma_f32_4x4x4_16b_bf16 v[68:71], a[46:47], a[46:47], v[68:71]
    v_mfma_f32_4x4x4_16b_bf16 v[76:79], v[168:169], v[84:85], v[76:79]
    v_mfma_f32_4x4x4_16b_bf16 v[80:83], v[170:171], v[84:85], v[80:83]
    v_mfma_f32_32x32x16_bf16 v[16:31], v[116:119], a[44:47], v[16:31]
    ds_read_b128 a[52:55], v133 offset:0
    ds_read_b64_tr_b16 v[104:105], v137 offset:31744
    ds_read_b64_tr_b16 v[106:107], v137 offset:32512
    s_mov_b64 exec, s[60:61]
    buffer_load_dwordx4 v8, s[8:11], s79 offen offset:2048 lds
    s_mov_b64 exec, -1
    s_add_u32 s79, s79, 245760
    s_cmp_eq_u32 s78, s77
    s_cselect_b32 s78, s52, s78
    s_cselect_b32 s79, s53, s79
    v_mfma_f32_32x32x16_bf16 v[32:47], v[120:123], a[44:47], v[32:47]
    ds_read_b64_tr_b16 v[108:109], v137 offset:31808
    ds_read_b64_tr_b16 v[110:111], v137 offset:32576
    ds_read_b64_tr_b16 v[112:113], v137 offset:31872
    v_mfma_f32_32x32x16_bf16 v[48:63], v[124:127], a[44:47], v[48:63]
    ds_read_b64_tr_b16 v[114:115], v137 offset:32640
    ds_read_b64_tr_b16 v[164:165], v73 offset:31744
    ds_read_b64_tr_b16 v[166:167], v73 offset:32512
    s_waitcnt lgkmcnt(6)
    v_mfma_f32_32x32x16_bf16 v[16:31], v[92:95], a[48:51], v[16:31]
    ds_read_b128 a[56:59], v134 offset:0
    ds_read_b64_tr_b16 v[116:117], v137 offset:34816
    ds_read_b64_tr_b16 v[118:119], v137 offset:35584
    s_add_u32 m0, s54, 28672
    s_add_u32 s63, s55, 28672
    buffer_load_dwordx4 v4, s[4:7], s78 offen lds
    v_mfma_f32_32x32x16_bf16 v[32:47], v[96:99], a[48:51], v[32:47]
    ds_read_b64_tr_b16 v[120:121], v137 offset:34880
    ds_read_b64_tr_b16 v[122:123], v137 offset:35648
    ds_read_b64_tr_b16 v[124:125], v137 offset:34944
    v_mfma_f32_32x32x16_bf16 v[48:63], v[100:103], a[48:51], v[48:63]
    ds_read_b64_tr_b16 v[126:127], v137 offset:35712
    ds_read_b64_tr_b16 v[168:169], v73 offset:34816
    ds_read_b64_tr_b16 v[170:171], v73 offset:35584
    buffer_load_dwordx4 v5, s[4:7], s78 offen offset:1024 lds
    buffer_load_dwordx4 v157, s[4:7], s78 offen offset:2048 lds
    s_waitcnt lgkmcnt(6)
    v_mfma_f32_4x4x4_16b_bf16 v[64:67], a[48:49], a[48:49], v[64:67]
    v_mfma_f32_4x4x4_16b_bf16 v[68:71], a[50:51], a[50:51], v[68:71]
    v_mfma_f32_4x4x4_16b_bf16 v[76:79], v[160:161], v[84:85], v[76:79]
    v_mfma_f32_4x4x4_16b_bf16 v[80:83], v[162:163], v[84:85], v[80:83]
    v_mfma_f32_4x4x4_16b_bf16 v[64:67], a[52:53], a[52:53], v[64:67]
    v_mfma_f32_4x4x4_16b_bf16 v[68:71], a[54:55], a[54:55], v[68:71]
    v_mfma_f32_4x4x4_16b_bf16 v[76:79], v[164:165], v[84:85], v[76:79]
    v_mfma_f32_4x4x4_16b_bf16 v[80:83], v[166:167], v[84:85], v[80:83]
    v_mfma_f32_32x32x16_bf16 v[16:31], v[104:107], a[52:55], v[16:31]
    ds_read_b128 a[60:63], v135 offset:0
    ds_read_b64_tr_b16 v[92:93], v137 offset:37888
    ds_read_b64_tr_b16 v[94:95], v137 offset:38656
    buffer_load_dwordx4 v158, s[4:7], s78 offen offset:3072 lds
    s_add_u32 s78, s78, 128
    v_mfma_f32_32x32x16_bf16 v[32:47], v[108:111], a[52:55], v[32:47]
    ds_read_b64_tr_b16 v[96:97], v137 offset:37952
    ds_read_b64_tr_b16 v[98:99], v137 offset:38720
    ds_read_b64_tr_b16 v[100:101], v137 offset:38016
    v_mfma_f32_32x32x16_bf16 v[48:63], v[112:115], a[52:55], v[48:63]
    ds_read_b64_tr_b16 v[102:103], v137 offset:38784
    ds_read_b64_tr_b16 v[160:161], v73 offset:37888
    ds_read_b64_tr_b16 v[162:163], v73 offset:38656
    s_mov_b32 m0, s63
    s_mov_b64 exec, s[56:57]
    buffer_load_dwordx4 v6, s[8:11], s79 offen lds
    s_mov_b64 exec, -1
    s_mov_b64 exec, s[58:59]
    buffer_load_dwordx4 v7, s[8:11], s79 offen offset:1024 lds
    s_mov_b64 exec, -1
    s_waitcnt lgkmcnt(6)
    s_waitcnt vmcnt(13)
    s_barrier
    v_mfma_f32_32x32x16_bf16 v[16:31], v[116:119], a[56:59], v[16:31]
    ds_read_b128 a[64:67], v132 offset:28672
    ds_read_b64_tr_b16 v[104:105], v138 offset:0
    ds_read_b64_tr_b16 v[106:107], v138 offset:768
    s_mov_b64 exec, s[60:61]
    buffer_load_dwordx4 v8, s[8:11], s79 offen offset:2048 lds
    s_mov_b64 exec, -1
    s_add_u32 s79, s79, 245760
    s_cmp_eq_u32 s78, s77
    s_cselect_b32 s78, s52, s78
    s_cselect_b32 s79, s53, s79
    v_mfma_f32_32x32x16_bf16 v[32:47], v[120:123], a[56:59], v[32:47]
    ds_read_b64_tr_b16 v[108:109], v138 offset:64
    ds_read_b64_tr_b16 v[110:111], v138 offset:832
    ds_read_b64_tr_b16 v[112:113], v138 offset:128
    v_mfma_f32_32x32x16_bf16 v[48:63], v[124:127], a[56:59], v[48:63]
    ds_read_b64_tr_b16 v[114:115], v138 offset:896
    ds_read_b64_tr_b16 v[164:165], v74 offset:0
    ds_read_b64_tr_b16 v[166:167], v74 offset:768
    v_mul_u32_u24 v9, 21846, v1
    v_lshrrev_b32 v9, 16, v9
    v_mul_u32_u24 v10, 3, v9
    v_sub_u32 v10, v1, v10
    s_lshl_b32 s62, s49, 2
    s_add_u32 s62, s62, s3
    s_mul_i32 s62, s62, 5
    v_add_u32 v9, s62, v9
    v_mul_u32_u24 v9, 3840, v9
    v_lshl_add_u32 v9, v10, 7, v9
    s_lshr_b32 s62, s48, 1
    s_mul_i32 s62, s62, 320
    s_and_b32 s62, s62, 0xffffff80
    s_mov_b32 exec_lo, 0x7fff
    s_mov_b32 exec_hi, 0
    buffer_load_dword v159, v9, s[8:11], s62 offen
    s_mov_b64 exec, -1
    s_waitcnt lgkmcnt(6)
    v_mfma_f32_4x4x4_16b_bf16 v[64:67], a[56:57], a[56:57], v[64:67]
    v_mfma_f32_4x4x4_16b_bf16 v[68:71], a[58:59], a[58:59], v[68:71]
    v_mfma_f32_4x4x4_16b_bf16 v[76:79], v[168:169], v[84:85], v[76:79]
    v_mfma_f32_4x4x4_16b_bf16 v[80:83], v[170:171], v[84:85], v[80:83]
    v_mfma_f32_4x4x4_16b_bf16 v[64:67], a[60:61], a[60:61], v[64:67]
    v_mfma_f32_4x4x4_16b_bf16 v[68:71], a[62:63], a[62:63], v[68:71]
    v_mfma_f32_4x4x4_16b_bf16 v[76:79], v[160:161], v[84:85], v[76:79]
    v_mfma_f32_4x4x4_16b_bf16 v[80:83], v[162:163], v[84:85], v[80:83]
    v_mfma_f32_32x32x16_bf16 v[16:31], v[92:95], a[60:63], v[16:31]
    ds_read_b128 a[68:71], v133 offset:28672
    ds_read_b64_tr_b16 v[116:117], v138 offset:3072
    ds_read_b64_tr_b16 v[118:119], v138 offset:3840
    v_mfma_f32_32x32x16_bf16 v[32:47], v[96:99], a[60:63], v[32:47]
    ds_read_b64_tr_b16 v[120:121], v138 offset:3136
    ds_read_b64_tr_b16 v[122:123], v138 offset:3904
    ds_read_b64_tr_b16 v[124:125], v138 offset:3200
    v_mfma_f32_32x32x16_bf16 v[48:63], v[100:103], a[60:63], v[48:63]
    ds_read_b64_tr_b16 v[126:127], v138 offset:3968
    ds_read_b64_tr_b16 v[168:169], v74 offset:3072
    ds_read_b64_tr_b16 v[170:171], v74 offset:3840
    s_waitcnt lgkmcnt(6)
    v_mfma_f32_32x32x16_bf16 v[16:31], v[104:107], a[64:67], v[16:31]
    ds_read_b128 a[72:75], v134 offset:28672
    ds_read_b64_tr_b16 v[92:93], v138 offset:6144
    ds_read_b64_tr_b16 v[94:95], v138 offset:6912
    s_add_u32 m0, s54, 57344
    s_add_u32 s63, s55, 57344
    buffer_load_dwordx4 v4, s[4:7], s78 offen lds
    v_mfma_f32_32x32x16_bf16 v[32:47], v[108:111], a[64:67], v[32:47]
    ds_read_b64_tr_b16 v[96:97], v138 offset:6208
    ds_read_b64_tr_b16 v[98:99], v138 offset:6976
    ds_read_b64_tr_b16 v[100:101], v138 offset:6272
    v_mfma_f32_32x32x16_bf16 v[48:63], v[112:115], a[64:67], v[48:63]
    ds_read_b64_tr_b16 v[102:103], v138 offset:7040
    ds_read_b64_tr_b16 v[160:161], v74 offset:6144
    ds_read_b64_tr_b16 v[162:163], v74 offset:6912
    buffer_load_dwordx4 v5, s[4:7], s78 offen offset:1024 lds
    s_waitcnt lgkmcnt(6)
    v_mfma_f32_4x4x4_16b_bf16 v[64:67], a[64:65], a[64:65], v[64:67]
    v_mfma_f32_4x4x4_16b_bf16 v[68:71], a[66:67], a[66:67], v[68:71]
    v_mfma_f32_4x4x4_16b_bf16 v[76:79], v[164:165], v[84:85], v[76:79]
    v_mfma_f32_4x4x4_16b_bf16 v[80:83], v[166:167], v[84:85], v[80:83]
    v_mfma_f32_4x4x4_16b_bf16 v[64:67], a[68:69], a[68:69], v[64:67]
    v_mfma_f32_4x4x4_16b_bf16 v[68:71], a[70:71], a[70:71], v[68:71]
    v_mfma_f32_4x4x4_16b_bf16 v[76:79], v[168:169], v[84:85], v[76:79]
    v_mfma_f32_4x4x4_16b_bf16 v[80:83], v[170:171], v[84:85], v[80:83]
    v_mfma_f32_32x32x16_bf16 v[16:31], v[116:119], a[68:71], v[16:31]
    ds_read_b128 a[76:79], v135 offset:28672
    ds_read_b64_tr_b16 v[104:105], v138 offset:9216
    ds_read_b64_tr_b16 v[106:107], v138 offset:9984
    buffer_load_dwordx4 v157, s[4:7], s78 offen offset:2048 lds
    v_mfma_f32_32x32x16_bf16 v[32:47], v[120:123], a[68:71], v[32:47]
    ds_read_b64_tr_b16 v[108:109], v138 offset:9280
    ds_read_b64_tr_b16 v[110:111], v138 offset:10048
    ds_read_b64_tr_b16 v[112:113], v138 offset:9344
    v_mfma_f32_32x32x16_bf16 v[48:63], v[124:127], a[68:71], v[48:63]
    ds_read_b64_tr_b16 v[114:115], v138 offset:10112
    ds_read_b64_tr_b16 v[164:165], v74 offset:9216
    ds_read_b64_tr_b16 v[166:167], v74 offset:9984
    buffer_load_dwordx4 v158, s[4:7], s78 offen offset:3072 lds
    s_add_u32 s78, s78, 128
    s_waitcnt lgkmcnt(6)
    s_waitcnt vmcnt(12)
    s_barrier
    v_mfma_f32_32x32x16_bf16 v[16:31], v[92:95], a[72:75], v[16:31]
    ds_read_b128 a[80:83], v128 offset:0
    ds_read_b64_tr_b16 v[116:117], v136 offset:0
    ds_read_b64_tr_b16 v[118:119], v136 offset:768
    s_mov_b32 m0, s63
    s_mov_b64 exec, s[56:57]
    buffer_load_dwordx4 v6, s[8:11], s79 offen lds
    s_mov_b64 exec, -1
    v_mfma_f32_32x32x16_bf16 v[32:47], v[96:99], a[72:75], v[32:47]
    ds_read_b64_tr_b16 v[120:121], v136 offset:64
    ds_read_b64_tr_b16 v[122:123], v136 offset:832
    ds_read_b64_tr_b16 v[124:125], v136 offset:128
    v_mfma_f32_32x32x16_bf16 v[48:63], v[100:103], a[72:75], v[48:63]
    ds_read_b64_tr_b16 v[126:127], v136 offset:896
    ds_read_b64_tr_b16 v[168:169], v72 offset:0
    ds_read_b64_tr_b16 v[170:171], v72 offset:768
    s_mov_b64 exec, s[58:59]
    buffer_load_dwordx4 v7, s[8:11], s79 offen offset:1024 lds
    s_mov_b64 exec, -1
    s_waitcnt lgkmcnt(6)
    v_mfma_f32_4x4x4_16b_bf16 v[64:67], a[72:73], a[72:73], v[64:67]
    v_mfma_f32_4x4x4_16b_bf16 v[68:71], a[74:75], a[74:75], v[68:71]
    v_mfma_f32_4x4x4_16b_bf16 v[76:79], v[160:161], v[84:85], v[76:79]
    v_mfma_f32_4x4x4_16b_bf16 v[80:83], v[162:163], v[84:85], v[80:83]
    v_mfma_f32_4x4x4_16b_bf16 v[64:67], a[76:77], a[76:77], v[64:67]
    v_mfma_f32_4x4x4_16b_bf16 v[68:71], a[78:79], a[78:79], v[68:71]
    v_mfma_f32_4x4x4_16b_bf16 v[76:79], v[164:165], v[84:85], v[76:79]
    v_mfma_f32_4x4x4_16b_bf16 v[80:83], v[166:167], v[84:85], v[80:83]
    v_mfma_f32_32x32x16_bf16 v[16:31], v[104:107], a[76:79], v[16:31]
    ds_read_b128 a[84:87], v129 offset:0
    ds_read_b64_tr_b16 v[92:93], v136 offset:3072
    ds_read_b64_tr_b16 v[94:95], v136 offset:3840
    s_mov_b64 exec, s[60:61]
    buffer_load_dwordx4 v8, s[8:11], s79 offen offset:2048 lds
    s_mov_b64 exec, -1
    s_add_u32 s79, s79, 245760
    s_cmp_eq_u32 s78, s77
    s_cselect_b32 s78, s52, s78
    s_cselect_b32 s79, s53, s79
    v_mfma_f32_32x32x16_bf16 v[32:47], v[108:111], a[76:79], v[32:47]
    ds_read_b64_tr_b16 v[96:97], v136 offset:3136
    ds_read_b64_tr_b16 v[98:99], v136 offset:3904
    ds_read_b64_tr_b16 v[100:101], v136 offset:3200
    v_mfma_f32_32x32x16_bf16 v[48:63], v[112:115], a[76:79], v[48:63]
    ds_read_b64_tr_b16 v[102:103], v136 offset:3968
    ds_read_b64_tr_b16 v[160:161], v72 offset:3072
    ds_read_b64_tr_b16 v[162:163], v72 offset:3840
    s_waitcnt lgkmcnt(6)
    v_mfma_f32_32x32x16_bf16 v[16:31], v[116:119], a[80:83], v[16:31]
    ds_read_b128 a[88:91], v130 offset:0
    ds_read_b64_tr_b16 v[104:105], v136 offset:6144
    ds_read_b64_tr_b16 v[106:107], v136 offset:6912
    s_add_u32 m0, s54, 86016
    s_add_u32 s63, s55, 86016
    buffer_load_dwordx4 v4, s[4:7], s78 offen lds
    v_mfma_f32_32x32x16_bf16 v[32:47], v[120:123], a[80:83], v[32:47]
    ds_read_b64_tr_b16 v[108:109], v136 offset:6208
    ds_read_b64_tr_b16 v[110:111], v136 offset:6976
    ds_read_b64_tr_b16 v[112:113], v136 offset:6272
    v_mfma_f32_32x32x16_bf16 v[48:63], v[124:127], a[80:83], v[48:63]
    ds_read_b64_tr_b16 v[114:115], v136 offset:7040
    ds_read_b64_tr_b16 v[164:165], v72 offset:6144
    ds_read_b64_tr_b16 v[166:167], v72 offset:6912
    buffer_load_dwordx4 v5, s[4:7], s78 offen offset:1024 lds
    s_waitcnt lgkmcnt(6)
    v_mfma_f32_4x4x4_16b_bf16 v[64:67], a[80:81], a[80:81], v[64:67]
    v_mfma_f32_4x4x4_16b_bf16 v[68:71], a[82:83], a[82:83], v[68:71]
    v_mfma_f32_4x4x4_16b_bf16 v[76:79], v[168:169], v[84:85], v[76:79]
    v_mfma_f32_4x4x4_16b_bf16 v[80:83], v[170:171], v[84:85], v[80:83]
    v_mfma_f32_4x4x4_16b_bf16 v[64:67], a[84:85], a[84:85], v[64:67]
    v_mfma_f32_4x4x4_16b_bf16 v[68:71], a[86:87], a[86:87], v[68:71]
    v_mfma_f32_4x4x4_16b_bf16 v[76:79], v[160:161], v[84:85], v[76:79]
    v_mfma_f32_4x4x4_16b_bf16 v[80:83], v[162:163], v[84:85], v[80:83]
    v_mfma_f32_32x32x16_bf16 v[16:31], v[92:95], a[84:87], v[16:31]
    ds_read_b128 a[92:95], v131 offset:0
    ds_read_b64_tr_b16 v[116:117], v136 offset:9216
    ds_read_b64_tr_b16 v[118:119], v136 offset:9984
    buffer_load_dwordx4 v157, s[4:7], s78 offen offset:2048 lds
    v_mfma_f32_32x32x16_bf16 v[32:47], v[96:99], a[84:87], v[32:47]
    ds_read_b64_tr_b16 v[120:121], v136 offset:9280
    ds_read_b64_tr_b16 v[122:123], v136 offset:10048
    ds_read_b64_tr_b16 v[124:125], v136 offset:9344
    v_mfma_f32_32x32x16_bf16 v[48:63], v[100:103], a[84:87], v[48:63]
    ds_read_b64_tr_b16 v[126:127], v136 offset:10112
    ds_read_b64_tr_b16 v[168:169], v72 offset:9216
    ds_read_b64_tr_b16 v[170:171], v72 offset:9984
    buffer_load_dwordx4 v158, s[4:7], s78 offen offset:3072 lds
    s_add_u32 s78, s78, 128
    s_waitcnt lgkmcnt(6)
    s_waitcnt vmcnt(12)
    s_barrier
    v_mfma_f32_32x32x16_bf16 v[16:31], v[104:107], a[88:91], v[16:31]
    ds_read_b128 a[96:99], v128 offset:28672
    ds_read_b64_tr_b16 v[92:93], v136 offset:28672
    ds_read_b64_tr_b16 v[94:95], v136 offset:29440
    s_mov_b32 m0, s63
    s_mov_b64 exec, s[56:57]
    buffer_load_dwordx4 v6, s[8:11], s79 offen lds
    s_mov_b64 exec, -1
    v_mfma_f32_32x32x16_bf16 v[32:47], v[108:111], a[88:91], v[32:47]
    ds_read_b64_tr_b16 v[96:97], v136 offset:28736
    ds_read_b64_tr_b16 v[98:99], v136 offset:29504
    ds_read_b64_tr_b16 v[100:101], v136 offset:28800
    v_mfma_f32_32x32x16_bf16 v[48:63], v[112:115], a[88:91], v[48:63]
    ds_read_b64_tr_b16 v[102:103], v136 offset:29568
    ds_read_b64_tr_b16 v[160:161], v72 offset:28672
    ds_read_b64_tr_b16 v[162:163], v72 offset:29440
    s_mov_b64 exec, s[58:59]
    buffer_load_dwordx4 v7, s[8:11], s79 offen offset:1024 lds
    s_mov_b64 exec, -1
    s_waitcnt lgkmcnt(6)
    v_mfma_f32_4x4x4_16b_bf16 v[64:67], a[88:89], a[88:89], v[64:67]
    v_mfma_f32_4x4x4_16b_bf16 v[68:71], a[90:91], a[90:91], v[68:71]
    v_mfma_f32_4x4x4_16b_bf16 v[76:79], v[164:165], v[84:85], v[76:79]
    v_mfma_f32_4x4x4_16b_bf16 v[80:83], v[166:167], v[84:85], v[80:83]
    v_mfma_f32_4x4x4_16b_bf16 v[64:67], a[92:93], a[92:93], v[64:67]
    v_mfma_f32_4x4x4_16b_bf16 v[68:71], a[94:95], a[94:95], v[68:71]
    v_mfma_f32_4x4x4_16b_bf16 v[76:79], v[168:169], v[84:85], v[76:79]
    v_mfma_f32_4x4x4_16b_bf16 v[80:83], v[170:171], v[84:85], v[80:83]
    v_mfma_f32_32x32x16_bf16 v[16:31], v[116:119], a[92:95], v[16:31]
    ds_read_b128 a[100:103], v129 offset:28672
    ds_read_b64_tr_b16 v[104:105], v136 offset:31744
    ds_read_b64_tr_b16 v[106:107], v136 offset:32512
    s_mov_b64 exec, s[60:61]
    buffer_load_dwordx4 v8, s[8:11], s79 offen offset:2048 lds
    s_mov_b64 exec, -1
    s_add_u32 s79, s79, 245760
    s_cmp_eq_u32 s78, s77
    s_cselect_b32 s78, s52, s78
    s_cselect_b32 s79, s53, s79
    v_mfma_f32_32x32x16_bf16 v[32:47], v[120:123], a[92:95], v[32:47]
    ds_read_b64_tr_b16 v[108:109], v136 offset:31808
    ds_read_b64_tr_b16 v[110:111], v136 offset:32576
    ds_read_b64_tr_b16 v[112:113], v136 offset:31872
    v_mfma_f32_32x32x16_bf16 v[48:63], v[124:127], a[92:95], v[48:63]
    ds_read_b64_tr_b16 v[114:115], v136 offset:32640
    ds_read_b64_tr_b16 v[164:165], v72 offset:31744
    ds_read_b64_tr_b16 v[166:167], v72 offset:32512
    s_waitcnt lgkmcnt(6)
    v_mfma_f32_32x32x16_bf16 v[16:31], v[92:95], a[96:99], v[16:31]
    ds_read_b128 a[104:107], v130 offset:28672
    ds_read_b64_tr_b16 v[116:117], v136 offset:34816
    ds_read_b64_tr_b16 v[118:119], v136 offset:35584
    s_add_u32 m0, s54, 114688
    s_add_u32 s63, s55, 114688
    buffer_load_dwordx4 v4, s[4:7], s78 offen lds
    v_mfma_f32_32x32x16_bf16 v[32:47], v[96:99], a[96:99], v[32:47]
    ds_read_b64_tr_b16 v[120:121], v136 offset:34880
    ds_read_b64_tr_b16 v[122:123], v136 offset:35648
    ds_read_b64_tr_b16 v[124:125], v136 offset:34944
    v_mfma_f32_32x32x16_bf16 v[48:63], v[100:103], a[96:99], v[48:63]
    ds_read_b64_tr_b16 v[126:127], v136 offset:35712
    ds_read_b64_tr_b16 v[168:169], v72 offset:34816
    ds_read_b64_tr_b16 v[170:171], v72 offset:35584
    buffer_load_dwordx4 v5, s[4:7], s78 offen offset:1024 lds
    buffer_load_dwordx4 v157, s[4:7], s78 offen offset:2048 lds
    s_waitcnt lgkmcnt(6)
    v_mfma_f32_4x4x4_16b_bf16 v[64:67], a[96:97], a[96:97], v[64:67]
    v_mfma_f32_4x4x4_16b_bf16 v[68:71], a[98:99], a[98:99], v[68:71]
    v_mfma_f32_4x4x4_16b_bf16 v[76:79], v[160:161], v[84:85], v[76:79]
    v_mfma_f32_4x4x4_16b_bf16 v[80:83], v[162:163], v[84:85], v[80:83]
    v_mfma_f32_4x4x4_16b_bf16 v[64:67], a[100:101], a[100:101], v[64:67]
    v_mfma_f32_4x4x4_16b_bf16 v[68:71], a[102:103], a[102:103], v[68:71]
    v_mfma_f32_4x4x4_16b_bf16 v[76:79], v[164:165], v[84:85], v[76:79]
    v_mfma_f32_4x4x4_16b_bf16 v[80:83], v[166:167], v[84:85], v[80:83]
    v_mfma_f32_32x32x16_bf16 v[16:31], v[104:107], a[100:103], v[16:31]
    ds_read_b128 a[108:111], v131 offset:28672
    ds_read_b64_tr_b16 v[92:93], v136 offset:37888
    ds_read_b64_tr_b16 v[94:95], v136 offset:38656
    buffer_load_dwordx4 v158, s[4:7], s78 offen offset:3072 lds
    s_add_u32 s78, s78, 128
    v_mfma_f32_32x32x16_bf16 v[32:47], v[108:111], a[100:103], v[32:47]
    ds_read_b64_tr_b16 v[96:97], v136 offset:37952
    ds_read_b64_tr_b16 v[98:99], v136 offset:38720
    ds_read_b64_tr_b16 v[100:101], v136 offset:38016
    v_mfma_f32_32x32x16_bf16 v[48:63], v[112:115], a[100:103], v[48:63]
    ds_read_b64_tr_b16 v[102:103], v136 offset:38784
    ds_read_b64_tr_b16 v[160:161], v72 offset:37888
    ds_read_b64_tr_b16 v[162:163], v72 offset:38656
    s_mov_b32 m0, s63
    s_mov_b64 exec, s[56:57]
    buffer_load_dwordx4 v6, s[8:11], s79 offen lds
    s_mov_b64 exec, -1
    s_mov_b64 exec, s[58:59]
    buffer_load_dwordx4 v7, s[8:11], s79 offen offset:1024 lds
    s_mov_b64 exec, -1
    s_waitcnt lgkmcnt(6)
    s_waitcnt vmcnt(13)
    s_barrier
    v_mfma_f32_32x32x16_bf16 v[16:31], v[116:119], a[104:107], v[16:31]
    ds_read_b128 a[112:115], v128 offset:57344
    ds_read_b64_tr_b16 v[104:105], v137 offset:0
    ds_read_b64_tr_b16 v[106:107], v137 offset:768
    s_mov_b64 exec, s[60:61]
    buffer_load_dwordx4 v8, s[8:11], s79 offen offset:2048 lds
    s_mov_b64 exec, -1
    s_add_u32 s79, s79, 245760
    s_cmp_eq_u32 s78, s77
    s_cselect_b32 s78, s52, s78
    s_cselect_b32 s79, s53, s79
    v_mfma_f32_32x32x16_bf16 v[32:47], v[120:123], a[104:107], v[32:47]
    ds_read_b64_tr_b16 v[108:109], v137 offset:64
    ds_read_b64_tr_b16 v[110:111], v137 offset:832
    ds_read_b64_tr_b16 v[112:113], v137 offset:128
    v_mfma_f32_32x32x16_bf16 v[48:63], v[124:127], a[104:107], v[48:63]
    ds_read_b64_tr_b16 v[114:115], v137 offset:896
    ds_read_b64_tr_b16 v[164:165], v73 offset:0
    ds_read_b64_tr_b16 v[166:167], v73 offset:768
    v_mov_b32 v75, 240
    buffer_load_dword v75, v75, s[40:43], 0 offen sc1
    s_waitcnt lgkmcnt(6)
    v_mfma_f32_4x4x4_16b_bf16 v[64:67], a[104:105], a[104:105], v[64:67]
    v_mfma_f32_4x4x4_16b_bf16 v[68:71], a[106:107], a[106:107], v[68:71]
    v_mfma_f32_4x4x4_16b_bf16 v[76:79], v[168:169], v[84:85], v[76:79]
    v_mfma_f32_4x4x4_16b_bf16 v[80:83], v[170:171], v[84:85], v[80:83]
    v_mfma_f32_4x4x4_16b_bf16 v[64:67], a[108:109], a[108:109], v[64:67]
    v_mfma_f32_4x4x4_16b_bf16 v[68:71], a[110:111], a[110:111], v[68:71]
    v_mfma_f32_4x4x4_16b_bf16 v[76:79], v[160:161], v[84:85], v[76:79]
    v_mfma_f32_4x4x4_16b_bf16 v[80:83], v[162:163], v[84:85], v[80:83]
    v_mfma_f32_32x32x16_bf16 v[16:31], v[92:95], a[108:111], v[16:31]
    ds_read_b128 a[116:119], v129 offset:57344
    ds_read_b64_tr_b16 v[116:117], v137 offset:3072
    ds_read_b64_tr_b16 v[118:119], v137 offset:3840
    v_mfma_f32_32x32x16_bf16 v[32:47], v[96:99], a[108:111], v[32:47]
    ds_read_b64_tr_b16 v[120:121], v137 offset:3136
    ds_read_b64_tr_b16 v[122:123], v137 offset:3904
    ds_read_b64_tr_b16 v[124:125], v137 offset:3200
    v_mfma_f32_32x32x16_bf16 v[48:63], v[100:103], a[108:111], v[48:63]
    ds_read_b64_tr_b16 v[126:127], v137 offset:3968
    ds_read_b64_tr_b16 v[168:169], v73 offset:3072
    ds_read_b64_tr_b16 v[170:171], v73 offset:3840
    s_waitcnt lgkmcnt(6)
    v_mfma_f32_32x32x16_bf16 v[16:31], v[104:107], a[112:115], v[16:31]
    ds_read_b128 a[120:123], v130 offset:57344
    ds_read_b64_tr_b16 v[92:93], v137 offset:6144
    ds_read_b64_tr_b16 v[94:95], v137 offset:6912
    v_mul_u32_u24 v9, 13108, v1
    v_lshrrev_b32 v9, 16, v9
    v_mul_u32_u24 v10, 5, v9
    v_sub_u32 v10, v1, v10
    v_mul_u32_u24 v11, 3456, v9
    v_lshl_add_u32 v11, v10, 7, v11
    s_mul_i32 s62, s48, 448
    s_and_b32 s62, s62, 0xffffff80
    s_lshl_b32 s64, s49, 2
    s_add_u32 s64, s64, s3
    s_mul_i32 s64, s64, 17280
    s_add_u32 s62, s62, s64
    s_mov_b32 exec_lo, 0x1ffffff
    s_mov_b32 exec_hi, 0
    buffer_load_dword v159, v11, s[24:27], s62 offen
    s_mov_b64 exec, -1
    v_mfma_f32_32x32x16_bf16 v[32:47], v[108:111], a[112:115], v[32:47]
    ds_read_b64_tr_b16 v[96:97], v137 offset:6208
    ds_read_b64_tr_b16 v[98:99], v137 offset:6976
    ds_read_b64_tr_b16 v[100:101], v137 offset:6272
    v_mfma_f32_32x32x16_bf16 v[48:63], v[112:115], a[112:115], v[48:63]
    ds_read_b64_tr_b16 v[102:103], v137 offset:7040
    ds_read_b64_tr_b16 v[160:161], v73 offset:6144
    ds_read_b64_tr_b16 v[162:163], v73 offset:6912
    s_mov_b32 exec_lo, 0x1ffffff
    s_mov_b32 exec_hi, 0
    buffer_load_dword v159, v11, s[28:31], s62 offen
    s_mov_b64 exec, -1
    v_mul_u32_u24 v9, 6554, v1
    v_lshrrev_b32 v9, 16, v9
    v_mul_u32_u24 v10, 10, v9
    v_sub_u32 v10, v1, v10
    v_mul_u32_u24 v12, 1280, v9
    v_lshl_add_u32 v12, v10, 7, v12
    s_mul_i32 s62, s48, 286720
    s_mul_i32 s64, s49, 7
    s_lshl_b32 s65, s3, 1
    s_add_u32 s64, s64, s65
    s_mul_i32 s64, s64, 1280
    s_add_u32 s62, s62, s64
    s_mov_b32 exec_lo, 0xfffff
    s_mov_b32 exec_hi, 0
    buffer_load_dword v159, v12, s[32:35], s62 offen
    s_mov_b64 exec, -1
    s_waitcnt lgkmcnt(6)
    v_mfma_f32_4x4x4_16b_bf16 v[64:67], a[112:113], a[112:113], v[64:67]
    v_mfma_f32_4x4x4_16b_bf16 v[68:71], a[114:115], a[114:115], v[68:71]
    v_mfma_f32_4x4x4_16b_bf16 v[76:79], v[164:165], v[84:85], v[76:79]
    v_mfma_f32_4x4x4_16b_bf16 v[80:83], v[166:167], v[84:85], v[80:83]
    v_mfma_f32_4x4x4_16b_bf16 v[64:67], a[116:117], a[116:117], v[64:67]
    v_mfma_f32_4x4x4_16b_bf16 v[68:71], a[118:119], a[118:119], v[68:71]
    v_mfma_f32_4x4x4_16b_bf16 v[76:79], v[168:169], v[84:85], v[76:79]
    v_mfma_f32_4x4x4_16b_bf16 v[80:83], v[170:171], v[84:85], v[80:83]
    v_mfma_f32_32x32x16_bf16 v[16:31], v[116:119], a[116:119], v[16:31]
    ds_read_b128 a[124:127], v131 offset:57344
    ds_read_b64_tr_b16 v[104:105], v137 offset:9216
    ds_read_b64_tr_b16 v[106:107], v137 offset:9984
    v_mfma_f32_32x32x16_bf16 v[32:47], v[120:123], a[116:119], v[32:47]
    ds_read_b64_tr_b16 v[108:109], v137 offset:9280
    ds_read_b64_tr_b16 v[110:111], v137 offset:10048
    ds_read_b64_tr_b16 v[112:113], v137 offset:9344
    v_mfma_f32_32x32x16_bf16 v[48:63], v[124:127], a[116:119], v[48:63]
    ds_read_b64_tr_b16 v[114:115], v137 offset:10112
    ds_read_b64_tr_b16 v[164:165], v73 offset:9216
    ds_read_b64_tr_b16 v[166:167], v73 offset:9984
    s_waitcnt lgkmcnt(6)
    s_waitcnt vmcnt(11)
    s_barrier
    v_mfma_f32_32x32x16_bf16 v[16:31], v[92:95], a[120:123], v[16:31]
    ds_read_b128 a[128:131], v132 offset:0
    ds_read_b64_tr_b16 v[116:117], v137 offset:28672
    ds_read_b64_tr_b16 v[118:119], v137 offset:29440
    v_mfma_f32_32x32x16_bf16 v[32:47], v[96:99], a[120:123], v[32:47]
    ds_read_b64_tr_b16 v[120:121], v137 offset:28736
    ds_read_b64_tr_b16 v[122:123], v137 offset:29504
    ds_read_b64_tr_b16 v[124:125], v137 offset:28800
    v_mfma_f32_32x32x16_bf16 v[48:63], v[100:103], a[120:123], v[48:63]
    ds_read_b64_tr_b16 v[126:127], v137 offset:29568
    ds_read_b64_tr_b16 v[168:169], v73 offset:28672
    ds_read_b64_tr_b16 v[170:171], v73 offset:29440
    s_waitcnt lgkmcnt(6)
    v_mfma_f32_4x4x4_16b_bf16 v[64:67], a[120:121], a[120:121], v[64:67]
    v_mfma_f32_4x4x4_16b_bf16 v[68:71], a[122:123], a[122:123], v[68:71]
    v_mfma_f32_4x4x4_16b_bf16 v[76:79], v[160:161], v[84:85], v[76:79]
    v_mfma_f32_4x4x4_16b_bf16 v[80:83], v[162:163], v[84:85], v[80:83]
    v_mfma_f32_4x4x4_16b_bf16 v[64:67], a[124:125], a[124:125], v[64:67]
    v_mfma_f32_4x4x4_16b_bf16 v[68:71], a[126:127], a[126:127], v[68:71]
    v_mfma_f32_4x4x4_16b_bf16 v[76:79], v[164:165], v[84:85], v[76:79]
    v_mfma_f32_4x4x4_16b_bf16 v[80:83], v[166:167], v[84:85], v[80:83]
    v_mfma_f32_32x32x16_bf16 v[16:31], v[104:107], a[124:127], v[16:31]
    ds_read_b128 a[132:135], v133 offset:0
    ds_read_b64_tr_b16 v[92:93], v137 offset:31744
    ds_read_b64_tr_b16 v[94:95], v137 offset:32512
    v_mfma_f32_32x32x16_bf16 v[32:47], v[108:111], a[124:127], v[32:47]
    ds_read_b64_tr_b16 v[96:97], v137 offset:31808
    ds_read_b64_tr_b16 v[98:99], v137 offset:32576
    ds_read_b64_tr_b16 v[100:101], v137 offset:31872
    v_mfma_f32_32x32x16_bf16 v[48:63], v[112:115], a[124:127], v[48:63]
    ds_read_b64_tr_b16 v[102:103], v137 offset:32640
    ds_read_b64_tr_b16 v[160:161], v73 offset:31744
    ds_read_b64_tr_b16 v[162:163], v73 offset:32512
    s_waitcnt lgkmcnt(6)
    v_mfma_f32_32x32x16_bf16 v[16:31], v[116:119], a[128:131], v[16:31]
    ds_read_b128 a[136:139], v134 offset:0
    ds_read_b64_tr_b16 v[104:105], v137 offset:34816
    ds_read_b64_tr_b16 v[106:107], v137 offset:35584
    v_mfma_f32_32x32x16_bf16 v[32:47], v[120:123], a[128:131], v[32:47]
    ds_read_b64_tr_b16 v[108:109], v137 offset:34880
    ds_read_b64_tr_b16 v[110:111], v137 offset:35648
    ds_read_b64_tr_b16 v[112:113], v137 offset:34944
    v_mfma_f32_32x32x16_bf16 v[48:63], v[124:127], a[128:131], v[48:63]
    ds_read_b64_tr_b16 v[114:115], v137 offset:35712
    ds_read_b64_tr_b16 v[164:165], v73 offset:34816
    ds_read_b64_tr_b16 v[166:167], v73 offset:35584
    s_waitcnt lgkmcnt(6)
    v_mfma_f32_4x4x4_16b_bf16 v[64:67], a[128:129], a[128:129], v[64:67]
    v_mfma_f32_4x4x4_16b_bf16 v[68:71], a[130:131], a[130:131], v[68:71]
    v_mfma_f32_4x4x4_16b_bf16 v[76:79], v[168:169], v[84:85], v[76:79]
    v_mfma_f32_4x4x4_16b_bf16 v[80:83], v[170:171], v[84:85], v[80:83]
    v_mfma_f32_4x4x4_16b_bf16 v[64:67], a[132:133], a[132:133], v[64:67]
    v_mfma_f32_4x4x4_16b_bf16 v[68:71], a[134:135], a[134:135], v[68:71]
    v_mfma_f32_4x4x4_16b_bf16 v[76:79], v[160:161], v[84:85], v[76:79]
    v_mfma_f32_4x4x4_16b_bf16 v[80:83], v[162:163], v[84:85], v[80:83]
    v_mfma_f32_32x32x16_bf16 v[16:31], v[92:95], a[132:135], v[16:31]
    ds_read_b128 a[140:143], v135 offset:0
    ds_read_b64_tr_b16 v[116:117], v137 offset:37888
    ds_read_b64_tr_b16 v[118:119], v137 offset:38656
    v_mfma_f32_32x32x16_bf16 v[32:47], v[96:99], a[132:135], v[32:47]
    ds_read_b64_tr_b16 v[120:121], v137 offset:37952
    ds_read_b64_tr_b16 v[122:123], v137 offset:38720
    ds_read_b64_tr_b16 v[124:125], v137 offset:38016
    v_mfma_f32_32x32x16_bf16 v[48:63], v[100:103], a[132:135], v[48:63]
    ds_read_b64_tr_b16 v[126:127], v137 offset:38784
    ds_read_b64_tr_b16 v[168:169], v73 offset:37888
    ds_read_b64_tr_b16 v[170:171], v73 offset:38656
    s_waitcnt lgkmcnt(6)
    s_waitcnt vmcnt(4)
    s_barrier
    v_mfma_f32_32x32x16_bf16 v[16:31], v[104:107], a[136:139], v[16:31]
    ds_read_b128 a[144:147], v132 offset:28672
    ds_read_b64_tr_b16 v[92:93], v138 offset:0
    ds_read_b64_tr_b16 v[94:95], v138 offset:768
    v_mfma_f32_32x32x16_bf16 v[32:47], v[108:111], a[136:139], v[32:47]
    ds_read_b64_tr_b16 v[96:97], v138 offset:64
    ds_read_b64_tr_b16 v[98:99], v138 offset:832
    ds_read_b64_tr_b16 v[100:101], v138 offset:128
    v_mfma_f32_32x32x16_bf16 v[48:63], v[112:115], a[136:139], v[48:63]
    ds_read_b64_tr_b16 v[102:103], v138 offset:896
    ds_read_b64_tr_b16 v[160:161], v74 offset:0
    ds_read_b64_tr_b16 v[162:163], v74 offset:768
    s_waitcnt lgkmcnt(6)
    v_mfma_f32_4x4x4_16b_bf16 v[64:67], a[136:137], a[136:137], v[64:67]
    v_mfma_f32_4x4x4_16b_bf16 v[68:71], a[138:139], a[138:139], v[68:71]
    v_mfma_f32_4x4x4_16b_bf16 v[76:79], v[164:165], v[84:85], v[76:79]
    v_mfma_f32_4x4x4_16b_bf16 v[80:83], v[166:167], v[84:85], v[80:83]
    v_mfma_f32_4x4x4_16b_bf16 v[64:67], a[140:141], a[140:141], v[64:67]
    v_mfma_f32_4x4x4_16b_bf16 v[68:71], a[142:143], a[142:143], v[68:71]
    v_mfma_f32_4x4x4_16b_bf16 v[76:79], v[168:169], v[84:85], v[76:79]
    v_mfma_f32_4x4x4_16b_bf16 v[80:83], v[170:171], v[84:85], v[80:83]
    v_mfma_f32_32x32x16_bf16 v[16:31], v[116:119], a[140:143], v[16:31]
    ds_read_b128 a[148:151], v133 offset:28672
    ds_read_b64_tr_b16 v[104:105], v138 offset:3072
    ds_read_b64_tr_b16 v[106:107], v138 offset:3840
    v_mfma_f32_32x32x16_bf16 v[32:47], v[120:123], a[140:143], v[32:47]
    ds_read_b64_tr_b16 v[108:109], v138 offset:3136
    ds_read_b64_tr_b16 v[110:111], v138 offset:3904
    ds_read_b64_tr_b16 v[112:113], v138 offset:3200
    v_mfma_f32_32x32x16_bf16 v[48:63], v[124:127], a[140:143], v[48:63]
    ds_read_b64_tr_b16 v[114:115], v138 offset:3968
    ds_read_b64_tr_b16 v[164:165], v74 offset:3072
    ds_read_b64_tr_b16 v[166:167], v74 offset:3840
    s_waitcnt lgkmcnt(6)
    v_mfma_f32_32x32x16_bf16 v[16:31], v[92:95], a[144:147], v[16:31]
    ds_read_b128 a[152:155], v134 offset:28672
    ds_read_b64_tr_b16 v[116:117], v138 offset:6144
    ds_read_b64_tr_b16 v[118:119], v138 offset:6912
    v_mfma_f32_32x32x16_bf16 v[32:47], v[96:99], a[144:147], v[32:47]
    ds_read_b64_tr_b16 v[120:121], v138 offset:6208
    ds_read_b64_tr_b16 v[122:123], v138 offset:6976
    ds_read_b64_tr_b16 v[124:125], v138 offset:6272
    v_mfma_f32_32x32x16_bf16 v[48:63], v[100:103], a[144:147], v[48:63]
    ds_read_b64_tr_b16 v[126:127], v138 offset:7040
    ds_read_b64_tr_b16 v[168:169], v74 offset:6144
    ds_read_b64_tr_b16 v[170:171], v74 offset:6912
    s_waitcnt lgkmcnt(6)
    v_mfma_f32_4x4x4_16b_bf16 v[64:67], a[144:145], a[144:145], v[64:67]
    v_mfma_f32_4x4x4_16b_bf16 v[68:71], a[146:147], a[146:147], v[68:71]
    v_mfma_f32_4x4x4_16b_bf16 v[76:79], v[160:161], v[84:85], v[76:79]
    v_mfma_f32_4x4x4_16b_bf16 v[80:83], v[162:163], v[84:85], v[80:83]
    v_mfma_f32_4x4x4_16b_bf16 v[64:67], a[148:149], a[148:149], v[64:67]
    v_mfma_f32_4x4x4_16b_bf16 v[68:71], a[150:151], a[150:151], v[68:71]
    v_mfma_f32_4x4x4_16b_bf16 v[76:79], v[164:165], v[84:85], v[76:79]
    v_mfma_f32_4x4x4_16b_bf16 v[80:83], v[166:167], v[84:85], v[80:83]
    v_mfma_f32_32x32x16_bf16 v[16:31], v[104:107], a[148:151], v[16:31]
    ds_read_b128 a[156:159], v135 offset:28672
    ds_read_b64_tr_b16 v[92:93], v138 offset:9216
    ds_read_b64_tr_b16 v[94:95], v138 offset:9984
    v_mfma_f32_32x32x16_bf16 v[32:47], v[108:111], a[148:151], v[32:47]
    ds_read_b64_tr_b16 v[96:97], v138 offset:9280
    ds_read_b64_tr_b16 v[98:99], v138 offset:10048
    ds_read_b64_tr_b16 v[100:101], v138 offset:9344
    v_mfma_f32_32x32x16_bf16 v[48:63], v[112:115], a[148:151], v[48:63]
    ds_read_b64_tr_b16 v[102:103], v138 offset:10112
    ds_read_b64_tr_b16 v[160:161], v74 offset:9216
    ds_read_b64_tr_b16 v[162:163], v74 offset:9984
    s_waitcnt lgkmcnt(6)
    v_mfma_f32_32x32x16_bf16 v[16:31], v[116:119], a[152:155], v[16:31]
    v_mfma_f32_32x32x16_bf16 v[32:47], v[120:123], a[152:155], v[32:47]
    v_mfma_f32_32x32x16_bf16 v[48:63], v[124:127], a[152:155], v[48:63]
    s_waitcnt lgkmcnt(0)
    v_mfma_f32_4x4x4_16b_bf16 v[64:67], a[152:153], a[152:153], v[64:67]
    v_mfma_f32_4x4x4_16b_bf16 v[68:71], a[154:155], a[154:155], v[68:71]
    v_mfma_f32_4x4x4_16b_bf16 v[76:79], v[168:169], v[84:85], v[76:79]
    v_mfma_f32_4x4x4_16b_bf16 v[80:83], v[170:171], v[84:85], v[80:83]
    v_mfma_f32_4x4x4_16b_bf16 v[64:67], a[156:157], a[156:157], v[64:67]
    v_mfma_f32_4x4x4_16b_bf16 v[68:71], a[158:159], a[158:159], v[68:71]
    v_mfma_f32_4x4x4_16b_bf16 v[76:79], v[160:161], v[84:85], v[76:79]
    v_mfma_f32_4x4x4_16b_bf16 v[80:83], v[162:163], v[84:85], v[80:83]
    v_mfma_f32_32x32x16_bf16 v[16:31], v[92:95], a[156:159], v[16:31]
    v_mfma_f32_32x32x16_bf16 v[32:47], v[96:99], a[156:159], v[32:47]
    v_mfma_f32_32x32x16_bf16 v[48:63], v[100:103], a[156:159], v[48:63]
    s_nop 1
    v_add_f32 v76, v76, v80
    v_add_f32 v77, v77, v81
    v_add_f32 v78, v78, v82
    v_add_f32 v79, v79, v83
    v_mov_b32 v80, v76
    v_mov_b32 v81, v77
    v_mov_b32 v82, v78
    v_mov_b32 v83, v79
    v_permlane32_swap_b32 v76, v80
    v_permlane32_swap_b32 v77, v81
    v_permlane32_swap_b32 v78, v82
    v_permlane32_swap_b32 v79, v83
    v_add_f32 v76, v76, v80
    v_add_f32 v77, v77, v81
    v_add_f32 v78, v78, v82
    v_add_f32 v79, v79, v83
    s_lshl_b32 s62, s3, 7
    s_add_u32 s62, s62, 150144
    v_lshl_add_u32 v9, v1, 2, s62
    s_mov_b32 exec_lo, 0x11111111
    s_mov_b32 exec_hi, 0
    ds_write_b128 v9, v[76:79]
    s_mov_b64 exec, -1
    v_add_f32 v64, v64, v68
    v_add_f32 v65, v65, v69
    v_add_f32 v66, v66, v70
    v_add_f32 v67, v67, v71
    s_mov_b32 s70, 0x22222222
    s_mov_b32 s71, 0x22222222
    v_cndmask_b32 v64, v64, v65, s[70:71]
    s_mov_b32 s70, 0x44444444
    s_mov_b32 s71, 0x44444444
    v_cndmask_b32 v64, v64, v66, s[70:71]
    s_mov_b32 s70, 0x88888888
    s_mov_b32 s71, 0x88888888
    v_cndmask_b32 v64, v64, v67, s[70:71]
    v_mov_b32 v65, v64
    v_mov_b32 v90, 0x3acccccd
    s_nop 0
    v_permlane32_swap_b32 v64, v65
    v_add_f32 v64, v64, v65
    v_mul_f32 v66, v56, v90
    v_mul_f32 v64, v64, v90
    v_fma_f32 v64, -v66, v66, v64
    v_max_f32 v64, 0, v64
    v_cvt_pk_bf16_f32 v64, v64, v64
    v_lshlrev_b32 v64, 16, v64
    v_add_f32 v64, 0x3727c5ac, v64
    v_cvt_pk_bf16_f32 v64, v64, v64
    v_lshlrev_b32 v64, 16, v64
    v_sqrt_f32 v64, v64
    s_nop 0
    v_cvt_pk_bf16_f32 v90, v64, v64
    v_lshlrev_b32 v90, 16, v90
    v_cvt_pk_bf16_f32 v91, v66, v66
    v_lshlrev_b32 v91, 16, v91
    v_rcp_f32 v88, v90
    v_sub_f32 v86, 0, v91
    s_waitcnt lgkmcnt(0)
    s_barrier
    s_add_u32 m0, s80, 0
    s_add_u32 s64, s81, 0
    buffer_load_dwordx4 v152, s[8:11], s64 offen lds
    v_lshlrev_b32 v9, 4, v3
    v_add_u32 v9, 150144, v9
    ds_read_b128 v[160:163], v9 offset:0
    ds_read_b128 v[164:167], v9 offset:32
    ds_read_b128 v[168:171], v9 offset:64
    ds_read_b128 v[172:175], v9 offset:96
    ds_read_b128 v[176:179], v9 offset:128
    ds_read_b128 v[180:183], v9 offset:160
    ds_read_b128 v[184:187], v9 offset:192
    ds_read_b128 v[188:191], v9 offset:224
    ds_read_b128 v[192:195], v9 offset:256
    ds_read_b128 v[196:199], v9 offset:288
    s_waitcnt lgkmcnt(9)
    v_pk_fma_f32 v[16:17], v[160:161], v[86:87], v[16:17] op_sel_hi:[1,0,1]
    v_pk_fma_f32 v[18:19], v[162:163], v[86:87], v[18:19] op_sel_hi:[1,0,1]
    v_pk_mul_f32 v[16:17], v[16:17], v[88:89] op_sel_hi:[1,0]
    v_pk_mul_f32 v[18:19], v[18:19], v[88:89] op_sel_hi:[1,0]
    s_waitcnt lgkmcnt(8)
    v_pk_fma_f32 v[20:21], v[164:165], v[86:87], v[20:21] op_sel_hi:[1,0,1]
    v_pk_fma_f32 v[22:23], v[166:167], v[86:87], v[22:23] op_sel_hi:[1,0,1]
    s_add_u32 m0, s80, 1024
    s_add_u32 s64, s81, 0
    buffer_load_dwordx4 v153, s[8:11], s64 offen lds
    v_pk_mul_f32 v[20:21], v[20:21], v[88:89] op_sel_hi:[1,0]
    v_pk_mul_f32 v[22:23], v[22:23], v[88:89] op_sel_hi:[1,0]
    s_waitcnt lgkmcnt(7)
    v_pk_fma_f32 v[24:25], v[168:169], v[86:87], v[24:25] op_sel_hi:[1,0,1]
    v_pk_fma_f32 v[26:27], v[170:171], v[86:87], v[26:27] op_sel_hi:[1,0,1]
    v_pk_mul_f32 v[24:25], v[24:25], v[88:89] op_sel_hi:[1,0]
    v_pk_mul_f32 v[26:27], v[26:27], v[88:89] op_sel_hi:[1,0]
    s_waitcnt lgkmcnt(6)
    v_pk_fma_f32 v[28:29], v[172:173], v[86:87], v[28:29] op_sel_hi:[1,0,1]
    v_pk_fma_f32 v[30:31], v[174:175], v[86:87], v[30:31] op_sel_hi:[1,0,1]
    v_pk_mul_f32 v[28:29], v[28:29], v[88:89] op_sel_hi:[1,0]
    v_pk_mul_f32 v[30:31], v[30:31], v[88:89] op_sel_hi:[1,0]
    s_waitcnt lgkmcnt(5)
    v_pk_fma_f32 v[32:33], v[176:177], v[86:87], v[32:33] op_sel_hi:[1,0,1]
    v_pk_fma_f32 v[34:35], v[178:179], v[86:87], v[34:35] op_sel_hi:[1,0,1]
    v_pk_mul_f32 v[32:33], v[32:33], v[88:89] op_sel_hi:[1,0]
    v_pk_mul_f32 v[34:35], v[34:35], v[88:89] op_sel_hi:[1,0]
    v_cvt_pk_bf16_f32 v244, v16, v17
    v_cvt_pk_bf16_f32 v245, v18, v19
    v_cvt_pk_bf16_f32 v246, v20, v21
    v_cvt_pk_bf16_f32 v247, v22, v23
    s_add_u32 m0, s80, 2048
    s_add_u32 s64, s81, 0
    buffer_load_dwordx4 v154, s[8:11], s64 offen lds
    v_cvt_pk_bf16_f32 v248, v24, v25
    v_cvt_pk_bf16_f32 v249, v26, v27
    v_cvt_pk_bf16_f32 v250, v28, v29
    v_cvt_pk_bf16_f32 v251, v30, v31
    v_cvt_pk_bf16_f32 v252, v32, v33
    v_cvt_pk_bf16_f32 v253, v34, v35
    v_mfma_f32_32x32x16_bf16 v[92:107], v[140:143], v[244:247], 0
    v_mfma_f32_32x32x16_bf16 v[108:123], v[146:149], v[248:251], 0
    v_mfma_f32_32x32x8_bf16 v[92:107], v[144:145], v[248:249], v[92:107]
    v_mfma_f32_32x32x8_bf16 v[108:123], v[150:151], v[252:253], v[108:123]
    s_waitcnt lgkmcnt(4)
    v_pk_fma_f32 v[36:37], v[180:181], v[86:87], v[36:37] op_sel_hi:[1,0,1]
    v_pk_fma_f32 v[38:39], v[182:183], v[86:87], v[38:39] op_sel_hi:[1,0,1]
    v_pk_mul_f32 v[36:37], v[36:37], v[88:89] op_sel_hi:[1,0]
    v_pk_mul_f32 v[38:39], v[38:39], v[88:89] op_sel_hi:[1,0]
    s_waitcnt lgkmcnt(3)
    v_pk_fma_f32 v[40:41], v[184:185], v[86:87], v[40:41] op_sel_hi:[1,0,1]
    v_pk_fma_f32 v[42:43], v[186:187], v[86:87], v[42:43] op_sel_hi:[1,0,1]
    v_pk_mul_f32 v[40:41], v[40:41], v[88:89] op_sel_hi:[1,0]
    v_pk_mul_f32 v[42:43], v[42:43], v[88:89] op_sel_hi:[1,0]
    s_waitcnt lgkmcnt(2)
    s_add_u32 m0, s80, 3072
    s_add_u32 s64, s81, 0
    buffer_load_dwordx4 v155, s[8:11], s64 offen lds
    v_pk_fma_f32 v[44:45], v[188:189], v[86:87], v[44:45] op_sel_hi:[1,0,1]
    v_pk_fma_f32 v[46:47], v[190:191], v[86:87], v[46:47] op_sel_hi:[1,0,1]
    v_pk_mul_f32 v[44:45], v[44:45], v[88:89] op_sel_hi:[1,0]
    v_pk_mul_f32 v[46:47], v[46:47], v[88:89] op_sel_hi:[1,0]
    s_waitcnt lgkmcnt(1)
    v_pk_fma_f32 v[48:49], v[192:193], v[86:87], v[48:49] op_sel_hi:[1,0,1]
    v_pk_fma_f32 v[50:51], v[194:195], v[86:87], v[50:51] op_sel_hi:[1,0,1]
    v_pk_mul_f32 v[48:49], v[48:49], v[88:89] op_sel_hi:[1,0]
    v_pk_mul_f32 v[50:51], v[50:51], v[88:89] op_sel_hi:[1,0]
    s_waitcnt lgkmcnt(0)
    v_pk_fma_f32 v[52:53], v[196:197], v[86:87], v[52:53] op_sel_hi:[1,0,1]
    v_pk_fma_f32 v[54:55], v[198:199], v[86:87], v[54:55] op_sel_hi:[1,0,1]
    v_pk_mul_f32 v[52:53], v[52:53], v[88:89] op_sel_hi:[1,0]
    v_pk_mul_f32 v[54:55], v[54:55], v[88:89] op_sel_hi:[1,0]
    v_accvgpr_read_b32 v11, a192
    v_mov_b32 v14, 0x3f80
    v_mov_b32 v15, 0
    v_lshl_add_u32 v12, v3, 4, v11
    v_lshl_add_u32 v13, v3, 3, v11
    ds_write_b64 v12, v[14:15] offset:272
    s_add_u32 m0, s80, 4096
    s_add_u32 s64, s81, 0
    buffer_load_dwordx4 v156, s[8:11], s64 offen lds
    v_cvt_pk_bf16_f32 v210, v36, v37
    v_cvt_pk_bf16_f32 v211, v38, v39
    ds_write_b64 v11, v[210:211] offset:192
    v_cvt_pk_bf16_f32 v212, v40, v41
    v_cvt_pk_bf16_f32 v213, v42, v43
    ds_write_b64 v11, v[212:213] offset:208
    v_cvt_pk_bf16_f32 v214, v44, v45
    v_cvt_pk_bf16_f32 v215, v46, v47
    ds_write_b64 v11, v[214:215] offset:224
    v_cvt_pk_bf16_f32 v216, v48, v49
    v_cvt_pk_bf16_f32 v217, v50, v51
    ds_write_b64 v11, v[216:217] offset:240
    v_cvt_pk_bf16_f32 v218, v52, v53
    v_cvt_pk_bf16_f32 v219, v54, v55
    ds_write_b64 v11, v[218:219] offset:256
    v_mov_b32 v124, 0x3fb8aa3b
    v_mov_b32 v126, 0xbfb8aa3b
    v_mov_b32 v230, 0
    v_mov_b32 v231, 0
    v_mov_b32 v242, 0
    v_mov_b32 v243, 0
    s_add_u32 m0, s80, 5120
    s_add_u32 s64, s81, 245760
    buffer_load_dwordx4 v152, s[8:11], s64 offen lds
    v_max3_f32 v200, v92, v93, v94
    v_min3_f32 v201, v92, v93, v94
    v_max3_f32 v200, v200, v95, v96
    v_min3_f32 v201, v201, v95, v96
    v_max3_f32 v200, v200, v97, v98
    v_min3_f32 v201, v201, v97, v98
    v_max3_f32 v200, v200, v99, v100
    v_min3_f32 v201, v201, v99, v100
    v_max_f32 v200, v200, v101
    v_min_f32 v201, v201, v101
    v_sub_f32 v201, 0, v201
    v_max3_f32 v204, v108, v109, v110
    v_min3_f32 v205, v108, v109, v110
    v_max3_f32 v204, v204, v111, v112
    v_min3_f32 v205, v205, v111, v112
    v_max3_f32 v204, v204, v113, v114
    v_min3_f32 v205, v205, v113, v114
    v_max3_f32 v204, v204, v115, v116
    v_min3_f32 v205, v205, v115, v116
    v_max_f32 v204, v204, v117
    v_min_f32 v205, v205, v117
    s_add_u32 m0, s80, 6144
    s_add_u32 s64, s81, 245760
    buffer_load_dwordx4 v153, s[8:11], s64 offen lds
    v_sub_f32 v205, 0, v205
    v_permlane32_swap_b32 v200, v201
    s_nop 0
    v_permlane32_swap_b32 v204, v205
    v_max_f32 v200, v200, v201
    v_max_f32 v204, v204, v205
    v_mov_b32 v201, v200
    v_mov_b32 v205, v204
    s_nop 0
    v_permlane32_swap_b32 v200, v201
    v_permlane32_swap_b32 v204, v205
    v_mul_f32 v202, v201, v126
    v_mul_f32 v200, v200, v126
    v_mul_f32 v206, v205, v126
    v_mul_f32 v204, v204, v126
    v_pk_fma_f32 v[160:161], v[92:93], v[124:125], v[200:201] op_sel_hi:[1,0,0]
    v_pk_fma_f32 v[170:171], v[92:93], v[126:127], v[202:203] op_sel_hi:[1,0,0]
    v_pk_fma_f32 v[162:163], v[94:95], v[124:125], v[200:201] op_sel_hi:[1,0,0]
    v_pk_fma_f32 v[172:173], v[94:95], v[126:127], v[202:203] op_sel_hi:[1,0,0]
    v_pk_fma_f32 v[164:165], v[96:97], v[124:125], v[200:201] op_sel_hi:[1,0,0]
    v_pk_fma_f32 v[174:175], v[96:97], v[126:127], v[202:203] op_sel_hi:[1,0,0]
    v_pk_fma_f32 v[166:167], v[98:99], v[124:125], v[200:201] op_sel_hi:[1,0,0]
    s_add_u32 m0, s80, 7168
    s_add_u32 s64, s81, 245760
    buffer_load_dwordx4 v154, s[8:11], s64 offen lds
    v_pk_fma_f32 v[176:177], v[98:99], v[126:127], v[202:203] op_sel_hi:[1,0,0]
    v_pk_fma_f32 v[168:169], v[100:101], v[124:125], v[200:201] op_sel_hi:[1,0,0]
    v_pk_fma_f32 v[178:179], v[100:101], v[126:127], v[202:203] op_sel_hi:[1,0,0]
    v_pk_fma_f32 v[180:181], v[108:109], v[124:125], v[204:205] op_sel_hi:[1,0,0]
    v_pk_fma_f32 v[190:191], v[108:109], v[126:127], v[206:207] op_sel_hi:[1,0,0]
    v_pk_fma_f32 v[182:183], v[110:111], v[124:125], v[204:205] op_sel_hi:[1,0,0]
    v_pk_fma_f32 v[192:193], v[110:111], v[126:127], v[206:207] op_sel_hi:[1,0,0]
    v_pk_fma_f32 v[184:185], v[112:113], v[124:125], v[204:205] op_sel_hi:[1,0,0]
    v_pk_fma_f32 v[194:195], v[112:113], v[126:127], v[206:207] op_sel_hi:[1,0,0]
    v_pk_fma_f32 v[186:187], v[114:115], v[124:125], v[204:205] op_sel_hi:[1,0,0]
    v_pk_fma_f32 v[196:197], v[114:115], v[126:127], v[206:207] op_sel_hi:[1,0,0]
    v_pk_fma_f32 v[188:189], v[116:117], v[124:125], v[204:205] op_sel_hi:[1,0,0]
    v_pk_fma_f32 v[198:199], v[116:117], v[126:127], v[206:207] op_sel_hi:[1,0,0]
    v_exp_f32 v160, v160
    v_exp_f32 v161, v161
    v_exp_f32 v162, v162
    v_exp_f32 v163, v163
    v_exp_f32 v164, v164
    v_exp_f32 v165, v165
    v_exp_f32 v166, v166
    v_exp_f32 v167, v167
    s_add_u32 m0, s80, 8192
    s_add_u32 s64, s81, 245760
    buffer_load_dwordx4 v155, s[8:11], s64 offen lds
    v_exp_f32 v168, v168
    v_exp_f32 v169, v169
    v_exp_f32 v170, v170
    v_exp_f32 v171, v171
    v_exp_f32 v172, v172
    v_exp_f32 v173, v173
    v_exp_f32 v174, v174
    v_exp_f32 v175, v175
    v_exp_f32 v176, v176
    v_exp_f32 v177, v177
    v_exp_f32 v178, v178
    v_exp_f32 v179, v179
    v_exp_f32 v180, v180
    v_exp_f32 v181, v181
    v_exp_f32 v182, v182
    v_exp_f32 v183, v183
    v_exp_f32 v184, v184
    v_exp_f32 v185, v185
    v_exp_f32 v186, v186
    v_exp_f32 v187, v187
    v_exp_f32 v188, v188
    s_add_u32 m0, s80, 9216
    s_add_u32 s64, s81, 245760
    buffer_load_dwordx4 v156, s[8:11], s64 offen lds
    v_exp_f32 v189, v189
    v_exp_f32 v190, v190
    v_exp_f32 v191, v191
    v_exp_f32 v192, v192
    v_exp_f32 v193, v193
    v_exp_f32 v194, v194
    v_exp_f32 v195, v195
    v_exp_f32 v196, v196
    v_exp_f32 v197, v197
    v_exp_f32 v198, v198
    v_exp_f32 v199, v199
    v_pk_add_f32 v[208:209], v[160:161], v[162:163]
    v_pk_add_f32 v[210:211], v[170:171], v[172:173]
    v_pk_add_f32 v[214:215], v[180:181], v[182:183]
    v_pk_add_f32 v[216:217], v[190:191], v[192:193]
    v_pk_add_f32 v[208:209], v[208:209], v[164:165]
    v_pk_add_f32 v[210:211], v[210:211], v[174:175]
    v_pk_add_f32 v[214:215], v[214:215], v[184:185]
    v_pk_add_f32 v[216:217], v[216:217], v[194:195]
    v_pk_add_f32 v[208:209], v[208:209], v[166:167]
    s_add_u32 m0, s80, 10240
    s_add_u32 s64, s81, 491520
    buffer_load_dwordx4 v152, s[8:11], s64 offen lds
    v_pk_add_f32 v[210:211], v[210:211], v[176:177]
    v_pk_add_f32 v[214:215], v[214:215], v[186:187]
    v_pk_add_f32 v[216:217], v[216:217], v[196:197]
    v_pk_add_f32 v[208:209], v[208:209], v[168:169]
    v_pk_add_f32 v[210:211], v[210:211], v[178:179]
    v_pk_add_f32 v[214:215], v[214:215], v[188:189]
    v_pk_add_f32 v[216:217], v[216:217], v[198:199]
    v_add_f32 v208, v208, v209
    v_add_f32 v209, v210, v211
    v_add_f32 v214, v214, v215
    v_add_f32 v215, v216, v217
    v_permlane32_swap_b32 v208, v209
    s_nop 0
    v_permlane32_swap_b32 v214, v215
    v_add_f32 v208, v208, v209
    v_add_f32 v214, v214, v215
    v_mov_b32 v210, v208
    v_mov_b32 v216, v214
    s_nop 0
    v_permlane32_swap_b32 v208, v210
    v_permlane32_swap_b32 v214, v216
    v_rcp_f32 v208, v208
    v_rcp_f32 v210, v210
    s_add_u32 m0, s80, 11264
    s_add_u32 s64, s81, 491520
    buffer_load_dwordx4 v153, s[8:11], s64 offen lds
    v_rcp_f32 v214, v214
    v_rcp_f32 v216, v216
    v_pk_mul_f32 v[160:161], v[160:161], v[208:209] op_sel_hi:[1,0]
    v_pk_mul_f32 v[170:171], v[170:171], v[210:211] op_sel_hi:[1,0]
    v_pk_mul_f32 v[162:163], v[162:163], v[208:209] op_sel_hi:[1,0]
    v_pk_mul_f32 v[172:173], v[172:173], v[210:211] op_sel_hi:[1,0]
    v_pk_mul_f32 v[164:165], v[164:165], v[208:209] op_sel_hi:[1,0]
    v_pk_mul_f32 v[174:175], v[174:175], v[210:211] op_sel_hi:[1,0]
    v_pk_mul_f32 v[166:167], v[166:167], v[208:209] op_sel_hi:[1,0]
    v_pk_mul_f32 v[176:177], v[176:177], v[210:211] op_sel_hi:[1,0]
    v_pk_mul_f32 v[168:169], v[168:169], v[208:209] op_sel_hi:[1,0]
    v_pk_mul_f32 v[178:179], v[178:179], v[210:211] op_sel_hi:[1,0]
    v_cvt_pk_bf16_f32 v220, v160, v161
    v_cvt_pk_bf16_f32 v221, v162, v163
    v_cvt_pk_bf16_f32 v222, v164, v165
    v_cvt_pk_bf16_f32 v223, v166, v167
    v_cvt_pk_bf16_f32 v224, v168, v169
    v_cvt_pk_bf16_f32 v225, v170, v171
    v_cvt_pk_bf16_f32 v226, v172, v173
    v_cvt_pk_bf16_f32 v227, v174, v175
    v_cvt_pk_bf16_f32 v228, v176, v177
    s_add_u32 m0, s80, 12288
    s_add_u32 s64, s81, 491520
    s_mov_b32 exec_hi, 0
    buffer_load_dwordx4 v154, s[8:11], s64 offen lds
    s_mov_b64 exec, -1
    v_cvt_pk_bf16_f32 v229, v178, v179
    v_pk_mul_f32 v[180:181], v[180:181], v[214:215] op_sel_hi:[1,0]
    v_pk_mul_f32 v[190:191], v[190:191], v[216:217] op_sel_hi:[1,0]
    v_pk_mul_f32 v[182:183], v[182:183], v[214:215] op_sel_hi:[1,0]
    v_pk_mul_f32 v[192:193], v[192:193], v[216:217] op_sel_hi:[1,0]
    v_pk_mul_f32 v[184:185], v[184:185], v[214:215] op_sel_hi:[1,0]
    v_pk_mul_f32 v[194:195], v[194:195], v[216:217] op_sel_hi:[1,0]
    v_pk_mul_f32 v[186:187], v[186:187], v[214:215] op_sel_hi:[1,0]
    v_pk_mul_f32 v[196:197], v[196:197], v[216:217] op_sel_hi:[1,0]
    v_pk_mul_f32 v[188:189], v[188:189], v[214:215] op_sel_hi:[1,0]
    v_pk_mul_f32 v[198:199], v[198:199], v[216:217] op_sel_hi:[1,0]
    v_cvt_pk_bf16_f32 v232, v180, v181
    v_cvt_pk_bf16_f32 v233, v182, v183
    v_cvt_pk_bf16_f32 v234, v184, v185
    v_cvt_pk_bf16_f32 v235, v186, v187
    v_cvt_pk_bf16_f32 v236, v188, v189
    v_cvt_pk_bf16_f32 v237, v190, v191
    v_cvt_pk_bf16_f32 v238, v192, v193
    v_cvt_pk_bf16_f32 v239, v194, v195
    v_cvt_pk_bf16_f32 v240, v196, v197
    v_cvt_pk_bf16_f32 v241, v198, v199
    ds_write_b128 v13, v[220:223] offset:0
    ds_write_b128 v13, v[224:227] offset:32
    ds_write_b128 v13, v[228:231] offset:64
    ds_write_b128 v13, v[232:235] offset:96
    ds_write_b128 v13, v[236:239] offset:128
    ds_write_b128 v13, v[240:243] offset:160
    v_accvgpr_read_b32 v160, a193
    v_accvgpr_read_b32 v161, a194
    v_accvgpr_read_b32 v9, a195
    v_cmp_gt_u32 vcc, 21, v2
    s_and_b32 s63, s3, 1
    s_mov_b64 s[68:69], vcc
    s_waitcnt vmcnt(0)
    s_waitcnt lgkmcnt(0)
    s_barrier
    ds_read_b64_tr_b16 v[164:165], v160 offset:0
    ds_read_b64_tr_b16 v[196:197], v161 offset:0
    ds_read_b64_tr_b16 v[166:167], v160 offset:336
    ds_read_b64_tr_b16 v[198:199], v161 offset:336
    ds_read_b64_tr_b16 v[168:169], v160 offset:5376
    ds_read_b64_tr_b16 v[200:201], v161 offset:5376
    ds_read_b64_tr_b16 v[170:171], v160 offset:5712
    ds_read_b64_tr_b16 v[202:203], v161 offset:5712
    ds_read_b64_tr_b16 v[172:173], v160 offset:10752
    ds_read_b64_tr_b16 v[204:205], v161 offset:10752
    ds_read_b64_tr_b16 v[174:175], v160 offset:11088
    ds_read_b64_tr_b16 v[206:207], v161 offset:11088
    s_waitcnt lgkmcnt(8)
    v_mfma_f32_32x32x16_bf16 v[92:107], v[164:167], v[196:199], 0
    ds_read_b64_tr_b16 v[176:177], v160 offset:16128
    ds_read_b64_tr_b16 v[208:209], v161 offset:16128
    ds_read_b64_tr_b16 v[178:179], v160 offset:16464
    ds_read_b64_tr_b16 v[210:211], v161 offset:16464
    s_waitcnt lgkmcnt(8)
    v_mfma_f32_32x32x16_bf16 v[92:107], v[168:171], v[200:203], v[92:107]
    ds_read_b64_tr_b16 v[180:181], v160 offset:21504
    ds_read_b64_tr_b16 v[212:213], v161 offset:21504
    ds_read_b64_tr_b16 v[182:183], v160 offset:21840
    ds_read_b64_tr_b16 v[214:215], v161 offset:21840
    s_waitcnt lgkmcnt(8)
    v_mfma_f32_32x32x16_bf16 v[92:107], v[172:175], v[204:207], v[92:107]
    ds_read_b64_tr_b16 v[184:185], v160 offset:26880
    ds_read_b64_tr_b16 v[216:217], v161 offset:26880
    ds_read_b64_tr_b16 v[186:187], v160 offset:27216
    ds_read_b64_tr_b16 v[218:219], v161 offset:27216
    s_waitcnt lgkmcnt(8)
    v_mfma_f32_32x32x16_bf16 v[92:107], v[176:179], v[208:211], v[92:107]
    ds_read_b64_tr_b16 v[188:189], v160 offset:32256
    ds_read_b64_tr_b16 v[220:221], v161 offset:32256
    ds_read_b64_tr_b16 v[190:191], v160 offset:32592
    ds_read_b64_tr_b16 v[222:223], v161 offset:32592
    s_waitcnt lgkmcnt(8)
    v_mfma_f32_32x32x16_bf16 v[92:107], v[180:183], v[212:215], v[92:107]
    ds_read_b64_tr_b16 v[192:193], v160 offset:37632
    ds_read_b64_tr_b16 v[224:225], v161 offset:37632
    ds_read_b64_tr_b16 v[194:195], v160 offset:37968
    ds_read_b64_tr_b16 v[226:227], v161 offset:37968
    s_waitcnt lgkmcnt(8)
    v_mfma_f32_32x32x16_bf16 v[92:107], v[184:187], v[216:219], v[92:107]
    s_waitcnt lgkmcnt(4)
    v_mfma_f32_32x32x16_bf16 v[92:107], v[188:191], v[220:223], v[92:107]
    s_waitcnt lgkmcnt(0)
    v_mfma_f32_32x32x16_bf16 v[92:107], v[192:195], v[224:227], v[92:107]
    s_cmp_lg_u32 s63, 0
    s_cbranch_scc1 L_kvft1
    s_mov_b64 exec, s[68:69]
    s_nop 8
    buffer_store_dwordx4 v[92:95], v9, s[44:47], s75 offen sc1
    buffer_store_dwordx4 v[96:99], v9, s[44:47], s75 offen offset:672 sc1
    buffer_store_dwordx4 v[100:103], v9, s[44:47], s75 offen offset:1344 sc1
    buffer_store_dwordx4 v[104:107], v9, s[44:47], s75 offen offset:2016 sc1
    s_branch L_kvdone
L_kvft1:
    s_and_b32 s68, s68, 0x1fffff
    s_mov_b32 s69, 0
    s_mov_b64 exec, s[68:69]
    s_nop 6
    buffer_store_dwordx4 v[92:95], v9, s[44:47], s75 offen offset:2688 sc1
    buffer_store_dwordx4 v[96:99], v9, s[44:47], s75 offen offset:3024 sc1
L_kvdone:
    s_mov_b64 exec, -1
    s_cmp_lg_u32 s51, 0
    s_cbranch_scc1 L_nostats
    s_lshl_b32 s62, s50, 7
    s_lshl_b32 s63, s3, 5
    s_add_u32 s62, s62, s63
    s_lshl_b32 s62, s62, 3
    s_add_u32 s62, s62, 5242880
    v_lshlrev_b32 v9, 3, v2
    v_mov_b32 v10, v91
    v_mov_b32 v11, v90
    s_mov_b32 exec_hi, 0
    buffer_store_dwordx2 v[10:11], v9, s[44:47], s62 offen sc1
    s_mov_b64 exec, -1
L_nostats:
    v_mul_u32_u24 v9, 6554, v1
    v_lshrrev_b32 v9, 16, v9
    v_mul_u32_u24 v10, 10, v9
    v_sub_u32 v10, v1, v10
    v_mul_u32_u24 v11, 1280, v9
    v_lshl_add_u32 v11, v10, 7, v11
    s_lshl_b32 s62, s49, 2
    s_add_u32 s62, s62, s3
    s_mul_i32 s62, s62, 6400
    s_mov_b32 exec_hi, 0x3ffff
    buffer_load_dword v159, v11, s[16:19], s62 offen
    s_mov_b64 exec, -1
    v_bfe_u32 v9, v1, 2, 2
    v_lshlrev_b32 v9, 1, v9
    v_add_u32 v9, v9, v3
    v_lshlrev_b32 v9, 1, v9
    v_mul_u32_u24 v9, 80, v9
    v_bfe_u32 v10, v1, 4, 1
    v_and_b32 v11, 3, v1
    v_lshl_add_u32 v10, v10, 2, v11
    v_lshl_add_u32 v9, v10, 3, v9
    v_add_u32 v132, 0, v9
    s_lshl_b32 s62, s3, 6
    v_add_u32 v133, s62, v132
    s_mul_i32 s13, s76, 5120
    v_accvgpr_read_b32 v152, a200
    v_accvgpr_read_b32 v153, a201
    v_accvgpr_read_b32 v154, a202
    v_accvgpr_read_b32 v155, a203
    v_accvgpr_read_b32 v156, a204
    v_add_u32 v128, s13, v132
    v_add_u32 v130, s13, v133
    s_add_u32 s13, s13, 5120
    s_cmp_eq_u32 s13, 51200
    s_cselect_b32 s13, 0, s13
    ds_read_b64_tr_b16 v[92:93], v128 offset:0
    ds_read_b64_tr_b16 v[94:95], v128 offset:80
    ds_read_b64_tr_b16 v[96:97], v128 offset:64
    ds_read_b64_tr_b16 v[98:99], v128 offset:144
    ds_read_b64_tr_b16 v[160:161], v130 offset:0
    ds_read_b64_tr_b16 v[162:163], v130 offset:80
    ds_read_b64_tr_b16 v[104:105], v128 offset:1280
    ds_read_b64_tr_b16 v[106:107], v128 offset:1360
    ds_read_b64_tr_b16 v[108:109], v128 offset:1344
    ds_read_b64_tr_b16 v[110:111], v128 offset:1424
    ds_read_b64_tr_b16 v[164:165], v130 offset:1280
    ds_read_b64_tr_b16 v[166:167], v130 offset:1360
    s_waitcnt lgkmcnt(6)
    v_mfma_f32_32x32x16_bf16 v[16:31], v[92:95], a[0:3], 0
    ds_read_b64_tr_b16 v[116:117], v128 offset:2560
    ds_read_b64_tr_b16 v[118:119], v128 offset:2640
    ds_read_b64_tr_b16 v[120:121], v128 offset:2624
    v_mfma_f32_32x32x16_bf16 v[32:47], v[96:99], a[0:3], 0
    ds_read_b64_tr_b16 v[122:123], v128 offset:2704
    ds_read_b64_tr_b16 v[168:169], v130 offset:2560
    ds_read_b64_tr_b16 v[170:171], v130 offset:2640
    v_add_u32 v129, s13, v132
    v_add_u32 v131, s13, v133
    s_add_u32 s13, s13, 5120
    s_cmp_eq_u32 s13, 51200
    s_cselect_b32 s13, 0, s13
    s_waitcnt lgkmcnt(6)
    v_mfma_f32_4x4x4_16b_bf16 v[76:79], v[160:161], v[84:85], 0
    v_mfma_f32_4x4x4_16b_bf16 v[80:83], v[162:163], v[84:85], 0
    ds_read_b64_tr_b16 v[92:93], v128 offset:3840
    v_mfma_f32_4x4x4_16b_bf16 v[76:79], v[164:165], v[84:85], v[76:79]
    v_mfma_f32_4x4x4_16b_bf16 v[80:83], v[166:167], v[84:85], v[80:83]
    v_mfma_f32_32x32x16_bf16 v[16:31], v[104:107], a[4:7], v[16:31]
    ds_read_b64_tr_b16 v[94:95], v128 offset:3920
    ds_read_b64_tr_b16 v[96:97], v128 offset:3904
    ds_read_b64_tr_b16 v[98:99], v128 offset:3984
    v_mfma_f32_32x32x16_bf16 v[32:47], v[108:111], a[4:7], v[32:47]
    ds_read_b64_tr_b16 v[160:161], v130 offset:3840
    ds_read_b64_tr_b16 v[162:163], v130 offset:3920
    s_waitcnt lgkmcnt(6)
    v_mfma_f32_32x32x16_bf16 v[16:31], v[116:119], a[8:11], v[16:31]
    ds_read_b64_tr_b16 v[104:105], v129 offset:0
    ds_read_b64_tr_b16 v[106:107], v129 offset:80
    ds_read_b64_tr_b16 v[108:109], v129 offset:64
    v_mfma_f32_32x32x16_bf16 v[32:47], v[120:123], a[8:11], v[32:47]
    ds_read_b64_tr_b16 v[110:111], v129 offset:144
    ds_read_b64_tr_b16 v[164:165], v131 offset:0
    ds_read_b64_tr_b16 v[166:167], v131 offset:80
    s_waitcnt lgkmcnt(6)
    v_mfma_f32_4x4x4_16b_bf16 v[76:79], v[168:169], v[84:85], v[76:79]
    v_mfma_f32_4x4x4_16b_bf16 v[80:83], v[170:171], v[84:85], v[80:83]
    ds_read_b64_tr_b16 v[116:117], v129 offset:1280
    v_mfma_f32_4x4x4_16b_bf16 v[76:79], v[160:161], v[84:85], v[76:79]
    v_mfma_f32_4x4x4_16b_bf16 v[80:83], v[162:163], v[84:85], v[80:83]
    v_mfma_f32_32x32x16_bf16 v[16:31], v[92:95], a[12:15], v[16:31]
    ds_read_b64_tr_b16 v[118:119], v129 offset:1360
    ds_read_b64_tr_b16 v[120:121], v129 offset:1344
    ds_read_b64_tr_b16 v[122:123], v129 offset:1424
    v_mfma_f32_32x32x16_bf16 v[32:47], v[96:99], a[12:15], v[32:47]
    ds_read_b64_tr_b16 v[168:169], v131 offset:1280
    ds_read_b64_tr_b16 v[170:171], v131 offset:1360
    s_waitcnt lgkmcnt(6)
    v_mfma_f32_32x32x16_bf16 v[16:31], v[104:107], a[16:19], v[16:31]
    ds_read_b64_tr_b16 v[92:93], v129 offset:2560
    ds_read_b64_tr_b16 v[94:95], v129 offset:2640
    ds_read_b64_tr_b16 v[96:97], v129 offset:2624
    v_mfma_f32_32x32x16_bf16 v[32:47], v[108:111], a[16:19], v[32:47]
    ds_read_b64_tr_b16 v[98:99], v129 offset:2704
    ds_read_b64_tr_b16 v[160:161], v131 offset:2560
    ds_read_b64_tr_b16 v[162:163], v131 offset:2640
    v_add_u32 v128, s13, v132
    v_add_u32 v130, s13, v133
    s_add_u32 s13, s13, 5120
    s_cmp_eq_u32 s13, 51200
    s_cselect_b32 s13, 0, s13
    s_waitcnt lgkmcnt(6)
    v_mfma_f32_4x4x4_16b_bf16 v[76:79], v[164:165], v[84:85], v[76:79]
    v_mfma_f32_4x4x4_16b_bf16 v[80:83], v[166:167], v[84:85], v[80:83]
    ds_read_b64_tr_b16 v[104:105], v129 offset:3840
    v_mfma_f32_4x4x4_16b_bf16 v[76:79], v[168:169], v[84:85], v[76:79]
    v_mfma_f32_4x4x4_16b_bf16 v[80:83], v[170:171], v[84:85], v[80:83]
    v_mfma_f32_32x32x16_bf16 v[16:31], v[116:119], a[20:23], v[16:31]
    ds_read_b64_tr_b16 v[106:107], v129 offset:3920
    ds_read_b64_tr_b16 v[108:109], v129 offset:3904
    ds_read_b64_tr_b16 v[110:111], v129 offset:3984
    v_mfma_f32_32x32x16_bf16 v[32:47], v[120:123], a[20:23], v[32:47]
    ds_read_b64_tr_b16 v[164:165], v131 offset:3840
    ds_read_b64_tr_b16 v[166:167], v131 offset:3920
    s_waitcnt lgkmcnt(6)
    v_mfma_f32_32x32x16_bf16 v[16:31], v[92:95], a[24:27], v[16:31]
    ds_read_b64_tr_b16 v[116:117], v128 offset:0
    ds_read_b64_tr_b16 v[118:119], v128 offset:80
    ds_read_b64_tr_b16 v[120:121], v128 offset:64
    v_mfma_f32_32x32x16_bf16 v[32:47], v[96:99], a[24:27], v[32:47]
    ds_read_b64_tr_b16 v[122:123], v128 offset:144
    ds_read_b64_tr_b16 v[168:169], v130 offset:0
    ds_read_b64_tr_b16 v[170:171], v130 offset:80
    s_waitcnt lgkmcnt(6)
    v_mfma_f32_4x4x4_16b_bf16 v[76:79], v[160:161], v[84:85], v[76:79]
    v_mfma_f32_4x4x4_16b_bf16 v[80:83], v[162:163], v[84:85], v[80:83]
    ds_read_b64_tr_b16 v[92:93], v128 offset:1280
    v_mfma_f32_4x4x4_16b_bf16 v[76:79], v[164:165], v[84:85], v[76:79]
    v_mfma_f32_4x4x4_16b_bf16 v[80:83], v[166:167], v[84:85], v[80:83]
    v_mfma_f32_32x32x16_bf16 v[16:31], v[104:107], a[28:31], v[16:31]
    ds_read_b64_tr_b16 v[94:95], v128 offset:1360
    ds_read_b64_tr_b16 v[96:97], v128 offset:1344
    ds_read_b64_tr_b16 v[98:99], v128 offset:1424
    v_mfma_f32_32x32x16_bf16 v[32:47], v[108:111], a[28:31], v[32:47]
    ds_read_b64_tr_b16 v[160:161], v130 offset:1280
    ds_read_b64_tr_b16 v[162:163], v130 offset:1360
    s_waitcnt lgkmcnt(6)
    v_mfma_f32_32x32x16_bf16 v[16:31], v[116:119], a[32:35], v[16:31]
    ds_read_b64_tr_b16 v[104:105], v128 offset:2560
    ds_read_b64_tr_b16 v[106:107], v128 offset:2640
    ds_read_b64_tr_b16 v[108:109], v128 offset:2624
    v_mfma_f32_32x32x16_bf16 v[32:47], v[120:123], a[32:35], v[32:47]
    ds_read_b64_tr_b16 v[110:111], v128 offset:2704
    ds_read_b64_tr_b16 v[164:165], v130 offset:2560
    ds_read_b64_tr_b16 v[166:167], v130 offset:2640
    v_add_u32 v129, s13, v132
    v_add_u32 v131, s13, v133
    s_add_u32 s13, s13, 5120
    s_cmp_eq_u32 s13, 51200
    s_cselect_b32 s13, 0, s13
    s_waitcnt lgkmcnt(6)
    v_mfma_f32_4x4x4_16b_bf16 v[76:79], v[168:169], v[84:85], v[76:79]
    v_mfma_f32_4x4x4_16b_bf16 v[80:83], v[170:171], v[84:85], v[80:83]
    ds_read_b64_tr_b16 v[116:117], v128 offset:3840
    v_mfma_f32_4x4x4_16b_bf16 v[76:79], v[160:161], v[84:85], v[76:79]
    v_mfma_f32_4x4x4_16b_bf16 v[80:83], v[162:163], v[84:85], v[80:83]
    v_mfma_f32_32x32x16_bf16 v[16:31], v[92:95], a[36:39], v[16:31]
    ds_read_b64_tr_b16 v[118:119], v128 offset:3920
    ds_read_b64_tr_b16 v[120:121], v128 offset:3904
    ds_read_b64_tr_b16 v[122:123], v128 offset:3984
    v_mfma_f32_32x32x16_bf16 v[32:47], v[96:99], a[36:39], v[32:47]
    ds_read_b64_tr_b16 v[168:169], v130 offset:3840
    ds_read_b64_tr_b16 v[170:171], v130 offset:3920
    s_waitcnt lgkmcnt(6)
    v_mfma_f32_32x32x16_bf16 v[16:31], v[104:107], a[40:43], v[16:31]
    ds_read_b64_tr_b16 v[92:93], v129 offset:0
    ds_read_b64_tr_b16 v[94:95], v129 offset:80
    ds_read_b64_tr_b16 v[96:97], v129 offset:64
    v_mfma_f32_32x32x16_bf16 v[32:47], v[108:111], a[40:43], v[32:47]
    ds_read_b64_tr_b16 v[98:99], v129 offset:144
    ds_read_b64_tr_b16 v[160:161], v131 offset:0
    ds_read_b64_tr_b16 v[162:163], v131 offset:80
    s_waitcnt lgkmcnt(6)
    v_mfma_f32_4x4x4_16b_bf16 v[76:79], v[164:165], v[84:85], v[76:79]
    v_mfma_f32_4x4x4_16b_bf16 v[80:83], v[166:167], v[84:85], v[80:83]
    ds_read_b64_tr_b16 v[104:105], v129 offset:1280
    v_mfma_f32_4x4x4_16b_bf16 v[76:79], v[168:169], v[84:85], v[76:79]
    v_mfma_f32_4x4x4_16b_bf16 v[80:83], v[170:171], v[84:85], v[80:83]
    v_mfma_f32_32x32x16_bf16 v[16:31], v[116:119], a[44:47], v[16:31]
    ds_read_b64_tr_b16 v[106:107], v129 offset:1360
    ds_read_b64_tr_b16 v[108:109], v129 offset:1344
    ds_read_b64_tr_b16 v[110:111], v129 offset:1424
    v_mfma_f32_32x32x16_bf16 v[32:47], v[120:123], a[44:47], v[32:47]
    ds_read_b64_tr_b16 v[164:165], v131 offset:1280
    ds_read_b64_tr_b16 v[166:167], v131 offset:1360
    s_waitcnt lgkmcnt(6)
    v_mfma_f32_32x32x16_bf16 v[16:31], v[92:95], a[48:51], v[16:31]
    ds_read_b64_tr_b16 v[116:117], v129 offset:2560
    ds_read_b64_tr_b16 v[118:119], v129 offset:2640
    ds_read_b64_tr_b16 v[120:121], v129 offset:2624
    v_mfma_f32_32x32x16_bf16 v[32:47], v[96:99], a[48:51], v[32:47]
    ds_read_b64_tr_b16 v[122:123], v129 offset:2704
    ds_read_b64_tr_b16 v[168:169], v131 offset:2560
    ds_read_b64_tr_b16 v[170:171], v131 offset:2640
    s_waitcnt vmcnt(1)
    v_readfirstlane_b32 s82, v75
    s_nop 0
    s_cmp_lg_u32 s82, 0
    s_cbranch_scc1 L_isready
    v_mov_b32 v9, 240
    s_mov_b32 s74, 0
L_poll_ready:
    buffer_load_dword v10, v9, s[40:43], 0 offen sc1
    s_add_u32 s74, s74, 1
    s_waitcnt vmcnt(0)
    v_readfirstlane_b32 s82, v10
    s_cmp_gt_u32 s74, 200000
    s_cbranch_scc1 L_isready
    s_cmp_eq_u32 s82, 0
    s_cbranch_scc1 L_poll_ready
L_isready:
    s_barrier
    s_cmp_lg_u32 s3, 0
    s_cbranch_scc1 L_nosig_kv
    s_add_u32 s62, s51, 0
    s_lshl_b32 s62, s62, 7
    v_mov_b32 v9, s62
    v_mov_b32 v10, 1
    s_mov_b64 exec, 1
    buffer_atomic_add v10, v9, s[44:47], 0 offen sc1
    s_mov_b64 exec, -1
L_nosig_kv:
    v_add_u32 v128, s13, v132
    v_add_u32 v130, s13, v133
    s_add_u32 s13, s13, 5120
    s_cmp_eq_u32 s13, 51200
    s_cselect_b32 s13, 0, s13
    s_waitcnt lgkmcnt(6)
    v_mfma_f32_4x4x4_16b_bf16 v[76:79], v[160:161], v[84:85], v[76:79]
    v_mfma_f32_4x4x4_16b_bf16 v[80:83], v[162:163], v[84:85], v[80:83]
    ds_read_b64_tr_b16 v[92:93], v129 offset:3840
    v_mfma_f32_4x4x4_16b_bf16 v[76:79], v[164:165], v[84:85], v[76:79]
    v_mfma_f32_4x4x4_16b_bf16 v[80:83], v[166:167], v[84:85], v[80:83]
    v_mfma_f32_32x32x16_bf16 v[16:31], v[104:107], a[52:55], v[16:31]
    ds_read_b64_tr_b16 v[94:95], v129 offset:3920
    ds_read_b64_tr_b16 v[96:97], v129 offset:3904
    ds_read_b64_tr_b16 v[98:99], v129 offset:3984
    v_mfma_f32_32x32x16_bf16 v[32:47], v[108:111], a[52:55], v[32:47]
    ds_read_b64_tr_b16 v[160:161], v131 offset:3840
    ds_read_b64_tr_b16 v[162:163], v131 offset:3920
    s_cmp_ge_u32 s22, 108
    s_cbranch_scc1 L_nomoeld0
    v_lshrrev_b32 v134, 1, v1
    v_mul_u32_u24 v134, 3456, v134
    v_and_b32 v10, 1, v1
    v_lshl_add_u32 v134, v10, 4, v134
    v_lshlrev_b32 v135, 3, v0
    s_and_b32 s62, s22, 3
    s_add_u32 s62, s62, 0
    s_cmp_ge_u32 s62, 5
    s_cselect_b32 s63, 5, 0
    s_sub_u32 s65, s62, s63
    s_mul_i32 s63, s3, 5
    s_add_u32 s65, s65, s63
    s_mul_i32 s64, s65, 110592
    s_lshl_b32 s62, s22, 5
    s_add_u32 s64, s64, s62
    s_lshl_b32 s63, s65, 10
    s_add_u32 m0, s63, 102400
    s_mul_i32 s62, s22, 20480
    buffer_load_dwordx4 v134, s[24:27], s64 offen lds
    s_add_u32 m0, s63, 123008
    v_cmp_gt_u32 vcc, 160, v0
    buffer_load_dwordx4 v134, s[28:31], s64 offen lds
    s_and_saveexec_b64 s[68:69], vcc
    s_cbranch_execz L_nomoeld0_x
    s_add_u32 s63, s62, 0
    buffer_load_dwordx2 a[160:161], v135, s[32:35], s63 offen
    s_add_u32 s63, s62, 1280
    buffer_load_dwordx2 a[162:163], v135, s[32:35], s63 offen
    s_add_u32 s63, s62, 2560
    buffer_load_dwordx2 a[164:165], v135, s[32:35], s63 offen
L_nomoeld0_x:
    s_mov_b64 exec, -1
L_nomoeld0:
    s_waitcnt lgkmcnt(6)
    v_mfma_f32_32x32x16_bf16 v[16:31], v[116:119], a[56:59], v[16:31]
    ds_read_b64_tr_b16 v[104:105], v128 offset:0
    ds_read_b64_tr_b16 v[106:107], v128 offset:80
    ds_read_b64_tr_b16 v[108:109], v128 offset:64
    v_mfma_f32_32x32x16_bf16 v[32:47], v[120:123], a[56:59], v[32:47]
    ds_read_b64_tr_b16 v[110:111], v128 offset:144
    ds_read_b64_tr_b16 v[164:165], v130 offset:0
    ds_read_b64_tr_b16 v[166:167], v130 offset:80
    s_waitcnt lgkmcnt(6)
    v_mfma_f32_4x4x4_16b_bf16 v[76:79], v[168:169], v[84:85], v[76:79]
    v_mfma_f32_4x4x4_16b_bf16 v[80:83], v[170:171], v[84:85], v[80:83]
    ds_read_b64_tr_b16 v[116:117], v128 offset:1280
    v_mfma_f32_4x4x4_16b_bf16 v[76:79], v[160:161], v[84:85], v[76:79]
    v_mfma_f32_4x4x4_16b_bf16 v[80:83], v[162:163], v[84:85], v[80:83]
    v_mfma_f32_32x32x16_bf16 v[16:31], v[92:95], a[60:63], v[16:31]
    ds_read_b64_tr_b16 v[118:119], v128 offset:1360
    ds_read_b64_tr_b16 v[120:121], v128 offset:1344
    ds_read_b64_tr_b16 v[122:123], v128 offset:1424
    v_mfma_f32_32x32x16_bf16 v[32:47], v[96:99], a[60:63], v[32:47]
    ds_read_b64_tr_b16 v[168:169], v130 offset:1280
    ds_read_b64_tr_b16 v[170:171], v130 offset:1360
    s_waitcnt lgkmcnt(6)
    v_mfma_f32_32x32x16_bf16 v[16:31], v[104:107], a[64:67], v[16:31]
    ds_read_b64_tr_b16 v[92:93], v128 offset:2560
    ds_read_b64_tr_b16 v[94:95], v128 offset:2640
    ds_read_b64_tr_b16 v[96:97], v128 offset:2624
    v_mfma_f32_32x32x16_bf16 v[32:47], v[108:111], a[64:67], v[32:47]
    ds_read_b64_tr_b16 v[98:99], v128 offset:2704
    ds_read_b64_tr_b16 v[160:161], v130 offset:2560
    ds_read_b64_tr_b16 v[162:163], v130 offset:2640
    v_add_u32 v129, s13, v132
    v_add_u32 v131, s13, v133
    s_add_u32 s13, s13, 5120
    s_cmp_eq_u32 s13, 51200
    s_cselect_b32 s13, 0, s13
    s_waitcnt lgkmcnt(6)
    v_mfma_f32_4x4x4_16b_bf16 v[76:79], v[164:165], v[84:85], v[76:79]
    v_mfma_f32_4x4x4_16b_bf16 v[80:83], v[166:167], v[84:85], v[80:83]
    ds_read_b64_tr_b16 v[104:105], v128 offset:3840
    v_mfma_f32_4x4x4_16b_bf16 v[76:79], v[168:169], v[84:85], v[76:79]
    v_mfma_f32_4x4x4_16b_bf16 v[80:83], v[170:171], v[84:85], v[80:83]
    v_mfma_f32_32x32x16_bf16 v[16:31], v[116:119], a[68:71], v[16:31]
    ds_read_b64_tr_b16 v[106:107], v128 offset:3920
    ds_read_b64_tr_b16 v[108:109], v128 offset:3904
    ds_read_b64_tr_b16 v[110:111], v128 offset:3984
    v_mfma_f32_32x32x16_bf16 v[32:47], v[120:123], a[68:71], v[32:47]
    ds_read_b64_tr_b16 v[164:165], v130 offset:3840
    ds_read_b64_tr_b16 v[166:167], v130 offset:3920
    s_waitcnt lgkmcnt(6)
    v_mfma_f32_32x32x16_bf16 v[16:31], v[92:95], a[72:75], v[16:31]
    ds_read_b64_tr_b16 v[116:117], v129 offset:0
    ds_read_b64_tr_b16 v[118:119], v129 offset:80
    ds_read_b64_tr_b16 v[120:121], v129 offset:64
    v_mfma_f32_32x32x16_bf16 v[32:47], v[96:99], a[72:75], v[32:47]
    ds_read_b64_tr_b16 v[122:123], v129 offset:144
    ds_read_b64_tr_b16 v[168:169], v131 offset:0
    ds_read_b64_tr_b16 v[170:171], v131 offset:80
    s_cmp_ge_u32 s22, 108
    s_cbranch_scc1 L_nomoeld1
    s_nop 0
    s_and_b32 s62, s22, 3
    s_add_u32 s62, s62, 1
    s_cmp_ge_u32 s62, 5
    s_cselect_b32 s63, 5, 0
    s_sub_u32 s65, s62, s63
    s_mul_i32 s63, s3, 5
    s_add_u32 s65, s65, s63
    s_mul_i32 s64, s65, 110592
    s_lshl_b32 s62, s22, 5
    s_add_u32 s64, s64, s62
    s_lshl_b32 s63, s65, 10
    s_add_u32 m0, s63, 102400
    s_mul_i32 s62, s22, 20480
    buffer_load_dwordx4 v134, s[24:27], s64 offen lds
    s_add_u32 m0, s63, 123008
    v_cmp_gt_u32 vcc, 160, v0
    buffer_load_dwordx4 v134, s[28:31], s64 offen lds
    s_and_saveexec_b64 s[68:69], vcc
    s_cbranch_execz L_nomoeld1_x
    s_add_u32 s63, s62, 3840
    buffer_load_dwordx2 a[166:167], v135, s[32:35], s63 offen
    s_add_u32 s63, s62, 5120
    buffer_load_dwordx2 a[168:169], v135, s[32:35], s63 offen
    s_add_u32 s63, s62, 6400
    buffer_load_dwordx2 a[170:171], v135, s[32:35], s63 offen
L_nomoeld1_x:
    s_mov_b64 exec, -1
L_nomoeld1:
    s_add_u32 s65, s3, 12
    s_mul_i32 s15, s65, 5120
    s_mul_i32 s66, s65, 13108
    s_lshr_b32 s66, s66, 16
    s_mul_i32 s66, s66, 153600
    s_mul_i32 s65, s65, 10240
    s_add_u32 s65, s65, s66
    s_add_u32 s76, s65, s14
    s_add_u32 m0, s15, 0
    s_nop 0
    buffer_load_dwordx4 v152, s[16:19], s76 offen lds
    s_waitcnt lgkmcnt(6)
    v_mfma_f32_4x4x4_16b_bf16 v[76:79], v[160:161], v[84:85], v[76:79]
    v_mfma_f32_4x4x4_16b_bf16 v[80:83], v[162:163], v[84:85], v[80:83]
    ds_read_b64_tr_b16 v[92:93], v129 offset:1280
    v_mfma_f32_4x4x4_16b_bf16 v[76:79], v[164:165], v[84:85], v[76:79]
    v_mfma_f32_4x4x4_16b_bf16 v[80:83], v[166:167], v[84:85], v[80:83]
    v_mfma_f32_32x32x16_bf16 v[16:31], v[104:107], a[76:79], v[16:31]
    ds_read_b64_tr_b16 v[94:95], v129 offset:1360
    ds_read_b64_tr_b16 v[96:97], v129 offset:1344
    ds_read_b64_tr_b16 v[98:99], v129 offset:1424
    v_mfma_f32_32x32x16_bf16 v[32:47], v[108:111], a[76:79], v[32:47]
    ds_read_b64_tr_b16 v[160:161], v131 offset:1280
    ds_read_b64_tr_b16 v[162:163], v131 offset:1360
    s_waitcnt lgkmcnt(6)
    v_mfma_f32_32x32x16_bf16 v[16:31], v[116:119], a[80:83], v[16:31]
    ds_read_b64_tr_b16 v[104:105], v129 offset:2560
    ds_read_b64_tr_b16 v[106:107], v129 offset:2640
    ds_read_b64_tr_b16 v[108:109], v129 offset:2624
    v_mfma_f32_32x32x16_bf16 v[32:47], v[120:123], a[80:83], v[32:47]
    ds_read_b64_tr_b16 v[110:111], v129 offset:2704
    ds_read_b64_tr_b16 v[164:165], v131 offset:2560
    ds_read_b64_tr_b16 v[166:167], v131 offset:2640
    s_add_u32 m0, s15, 1024
    s_nop 0
    buffer_load_dwordx4 v153, s[16:19], s76 offen lds
    v_add_u32 v128, s13, v132
    v_add_u32 v130, s13, v133
    s_add_u32 s13, s13, 5120
    s_cmp_eq_u32 s13, 51200
    s_cselect_b32 s13, 0, s13
    s_waitcnt lgkmcnt(6)
    v_mfma_f32_4x4x4_16b_bf16 v[76:79], v[168:169], v[84:85], v[76:79]
    v_mfma_f32_4x4x4_16b_bf16 v[80:83], v[170:171], v[84:85], v[80:83]
    ds_read_b64_tr_b16 v[116:117], v129 offset:3840
    v_mfma_f32_4x4x4_16b_bf16 v[76:79], v[160:161], v[84:85], v[76:79]
    v_mfma_f32_4x4x4_16b_bf16 v[80:83], v[162:163], v[84:85], v[80:83]
    v_mfma_f32_32x32x16_bf16 v[16:31], v[92:95], a[84:87], v[16:31]
    ds_read_b64_tr_b16 v[118:119], v129 offset:3920
    ds_read_b64_tr_b16 v[120:121], v129 offset:3904
    ds_read_b64_tr_b16 v[122:123], v129 offset:3984
    v_mfma_f32_32x32x16_bf16 v[32:47], v[96:99], a[84:87], v[32:47]
    ds_read_b64_tr_b16 v[168:169], v131 offset:3840
    ds_read_b64_tr_b16 v[170:171], v131 offset:3920
    s_waitcnt lgkmcnt(6)
    v_mfma_f32_32x32x16_bf16 v[16:31], v[104:107], a[88:91], v[16:31]
    ds_read_b64_tr_b16 v[92:93], v128 offset:0
    ds_read_b64_tr_b16 v[94:95], v128 offset:80
    ds_read_b64_tr_b16 v[96:97], v128 offset:64
    v_mfma_f32_32x32x16_bf16 v[32:47], v[108:111], a[88:91], v[32:47]
    ds_read_b64_tr_b16 v[98:99], v128 offset:144
    ds_read_b64_tr_b16 v[160:161], v130 offset:0
    ds_read_b64_tr_b16 v[162:163], v130 offset:80
    s_add_u32 m0, s15, 2048
    s_nop 0
    buffer_load_dwordx4 v154, s[16:19], s76 offen lds
    s_waitcnt lgkmcnt(6)
    v_mfma_f32_4x4x4_16b_bf16 v[76:79], v[164:165], v[84:85], v[76:79]
    v_mfma_f32_4x4x4_16b_bf16 v[80:83], v[166:167], v[84:85], v[80:83]
    ds_read_b64_tr_b16 v[104:105], v128 offset:1280
    v_mfma_f32_4x4x4_16b_bf16 v[76:79], v[168:169], v[84:85], v[76:79]
    v_mfma_f32_4x4x4_16b_bf16 v[80:83], v[170:171], v[84:85], v[80:83]
    v_mfma_f32_32x32x16_bf16 v[16:31], v[116:119], a[92:95], v[16:31]
    ds_read_b64_tr_b16 v[106:107], v128 offset:1360
    ds_read_b64_tr_b16 v[108:109], v128 offset:1344
    ds_read_b64_tr_b16 v[110:111], v128 offset:1424
    v_mfma_f32_32x32x16_bf16 v[32:47], v[120:123], a[92:95], v[32:47]
    ds_read_b64_tr_b16 v[164:165], v130 offset:1280
    ds_read_b64_tr_b16 v[166:167], v130 offset:1360
    s_cmp_ge_u32 s22, 108
    s_cbranch_scc1 L_nomoeld2
    s_nop 0
    s_and_b32 s62, s22, 3
    s_add_u32 s62, s62, 2
    s_cmp_ge_u32 s62, 5
    s_cselect_b32 s63, 5, 0
    s_sub_u32 s65, s62, s63
    s_mul_i32 s63, s3, 5
    s_add_u32 s65, s65, s63
    s_mul_i32 s64, s65, 110592
    s_lshl_b32 s62, s22, 5
    s_add_u32 s64, s64, s62
    s_lshl_b32 s63, s65, 10
    s_add_u32 m0, s63, 102400
    s_mul_i32 s62, s22, 20480
    buffer_load_dwordx4 v134, s[24:27], s64 offen lds
    s_add_u32 m0, s63, 123008
    v_cmp_gt_u32 vcc, 160, v0
    buffer_load_dwordx4 v134, s[28:31], s64 offen lds
    s_and_saveexec_b64 s[68:69], vcc
    s_cbranch_execz L_nomoeld2_x
    s_add_u32 s63, s62, 7680
    buffer_load_dwordx2 a[172:173], v135, s[32:35], s63 offen
    s_add_u32 s63, s62, 8960
    buffer_load_dwordx2 a[174:175], v135, s[32:35], s63 offen
    s_add_u32 s63, s62, 10240
    buffer_load_dwordx2 a[176:177], v135, s[32:35], s63 offen
L_nomoeld2_x:
    s_mov_b64 exec, -1
L_nomoeld2:
    s_waitcnt lgkmcnt(6)
    v_mfma_f32_32x32x16_bf16 v[16:31], v[92:95], a[96:99], v[16:31]
    ds_read_b64_tr_b16 v[116:117], v128 offset:2560
    ds_read_b64_tr_b16 v[118:119], v128 offset:2640
    ds_read_b64_tr_b16 v[120:121], v128 offset:2624
    v_mfma_f32_32x32x16_bf16 v[32:47], v[96:99], a[96:99], v[32:47]
    ds_read_b64_tr_b16 v[122:123], v128 offset:2704
    ds_read_b64_tr_b16 v[168:169], v130 offset:2560
    ds_read_b64_tr_b16 v[170:171], v130 offset:2640
    s_add_u32 m0, s15, 3072
    s_nop 0
    buffer_load_dwordx4 v155, s[16:19], s76 offen lds
    v_add_u32 v129, s13, v132
    v_add_u32 v131, s13, v133
    s_add_u32 s13, s13, 5120
    s_cmp_eq_u32 s13, 51200
    s_cselect_b32 s13, 0, s13
    s_waitcnt lgkmcnt(6)
    v_mfma_f32_4x4x4_16b_bf16 v[76:79], v[160:161], v[84:85], v[76:79]
    v_mfma_f32_4x4x4_16b_bf16 v[80:83], v[162:163], v[84:85], v[80:83]
    ds_read_b64_tr_b16 v[92:93], v128 offset:3840
    v_mfma_f32_4x4x4_16b_bf16 v[76:79], v[164:165], v[84:85], v[76:79]
    v_mfma_f32_4x4x4_16b_bf16 v[80:83], v[166:167], v[84:85], v[80:83]
    v_mfma_f32_32x32x16_bf16 v[16:31], v[104:107], a[100:103], v[16:31]
    ds_read_b64_tr_b16 v[94:95], v128 offset:3920
    ds_read_b64_tr_b16 v[96:97], v128 offset:3904
    ds_read_b64_tr_b16 v[98:99], v128 offset:3984
    v_mfma_f32_32x32x16_bf16 v[32:47], v[108:111], a[100:103], v[32:47]
    ds_read_b64_tr_b16 v[160:161], v130 offset:3840
    ds_read_b64_tr_b16 v[162:163], v130 offset:3920
    s_waitcnt lgkmcnt(6)
    v_mfma_f32_32x32x16_bf16 v[16:31], v[116:119], a[104:107], v[16:31]
    ds_read_b64_tr_b16 v[104:105], v129 offset:0
    ds_read_b64_tr_b16 v[106:107], v129 offset:80
    ds_read_b64_tr_b16 v[108:109], v129 offset:64
    v_mfma_f32_32x32x16_bf16 v[32:47], v[120:123], a[104:107], v[32:47]
    ds_read_b64_tr_b16 v[110:111], v129 offset:144
    ds_read_b64_tr_b16 v[164:165], v131 offset:0
    ds_read_b64_tr_b16 v[166:167], v131 offset:80
    s_add_u32 m0, s15, 4096
    s_nop 0
    buffer_load_dwordx4 v156, s[16:19], s76 offen lds
    s_waitcnt lgkmcnt(6)
    v_mfma_f32_4x4x4_16b_bf16 v[76:79], v[168:169], v[84:85], v[76:79]
    v_mfma_f32_4x4x4_16b_bf16 v[80:83], v[170:171], v[84:85], v[80:83]
    ds_read_b64_tr_b16 v[116:117], v129 offset:1280
    v_mfma_f32_4x4x4_16b_bf16 v[76:79], v[160:161], v[84:85], v[76:79]
    v_mfma_f32_4x4x4_16b_bf16 v[80:83], v[162:163], v[84:85], v[80:83]
    v_mfma_f32_32x32x16_bf16 v[16:31], v[92:95], a[108:111], v[16:31]
    ds_read_b64_tr_b16 v[118:119], v129 offset:1360
    ds_read_b64_tr_b16 v[120:121], v129 offset:1344
    ds_read_b64_tr_b16 v[122:123], v129 offset:1424
    v_mfma_f32_32x32x16_bf16 v[32:47], v[96:99], a[108:111], v[32:47]
    ds_read_b64_tr_b16 v[168:169], v131 offset:1280
    ds_read_b64_tr_b16 v[170:171], v131 offset:1360
    s_waitcnt lgkmcnt(6)
    v_mfma_f32_32x32x16_bf16 v[16:31], v[104:107], a[112:115], v[16:31]
    ds_read_b64_tr_b16 v[92:93], v129 offset:2560
    ds_read_b64_tr_b16 v[94:95], v129 offset:2640
    ds_read_b64_tr_b16 v[96:97], v129 offset:2624
    v_mfma_f32_32x32x16_bf16 v[32:47], v[108:111], a[112:115], v[32:47]
    ds_read_b64_tr_b16 v[98:99], v129 offset:2704
    ds_read_b64_tr_b16 v[160:161], v131 offset:2560
    ds_read_b64_tr_b16 v[162:163], v131 offset:2640
    s_cmp_ge_u32 s22, 108
    s_cbranch_scc1 L_nomoeld3
    s_nop 0
    s_and_b32 s62, s22, 3
    s_add_u32 s62, s62, 3
    s_cmp_ge_u32 s62, 5
    s_cselect_b32 s63, 5, 0
    s_sub_u32 s65, s62, s63
    s_mul_i32 s63, s3, 5
    s_add_u32 s65, s65, s63
    s_mul_i32 s64, s65, 110592
    s_lshl_b32 s62, s22, 5
    s_add_u32 s64, s64, s62
    s_lshl_b32 s63, s65, 10
    s_add_u32 m0, s63, 102400
    s_mul_i32 s62, s22, 20480
    buffer_load_dwordx4 v134, s[24:27], s64 offen lds
    s_add_u32 m0, s63, 123008
    v_cmp_gt_u32 vcc, 160, v0
    buffer_load_dwordx4 v134, s[28:31], s64 offen lds
    s_and_saveexec_b64 s[68:69], vcc
    s_cbranch_execz L_nomoeld3_x
    s_add_u32 s63, s62, 11520
    buffer_load_dwordx2 a[178:179], v135, s[32:35], s63 offen
    s_add_u32 s63, s62, 12800
    buffer_load_dwordx2 a[180:181], v135, s[32:35], s63 offen
    s_add_u32 s63, s62, 14080
    buffer_load_dwordx2 a[182:183], v135, s[32:35], s63 offen
L_nomoeld3_x:
    s_mov_b64 exec, -1
L_nomoeld3:
    s_add_u32 s65, s3, 16
    s_mul_i32 s15, s65, 5120
    s_mul_i32 s66, s65, 13108
    s_lshr_b32 s66, s66, 16
    s_mul_i32 s66, s66, 153600
    s_mul_i32 s65, s65, 10240
    s_add_u32 s65, s65, s66
    s_add_u32 s76, s65, s14
    s_add_u32 m0, s15, 0
    s_nop 0
    buffer_load_dwordx4 v152, s[16:19], s76 offen lds
    v_add_u32 v128, s13, v132
    v_add_u32 v130, s13, v133
    s_add_u32 s13, s13, 5120
    s_cmp_eq_u32 s13, 51200
    s_cselect_b32 s13, 0, s13
    s_waitcnt lgkmcnt(6)
    v_mfma_f32_4x4x4_16b_bf16 v[76:79], v[164:165], v[84:85], v[76:79]
    v_mfma_f32_4x4x4_16b_bf16 v[80:83], v[166:167], v[84:85], v[80:83]
    ds_read_b64_tr_b16 v[104:105], v129 offset:3840
    v_mfma_f32_4x4x4_16b_bf16 v[76:79], v[168:169], v[84:85], v[76:79]
    v_mfma_f32_4x4x4_16b_bf16 v[80:83], v[170:171], v[84:85], v[80:83]
    v_mfma_f32_32x32x16_bf16 v[16:31], v[116:119], a[116:119], v[16:31]
    ds_read_b64_tr_b16 v[106:107], v129 offset:3920
    ds_read_b64_tr_b16 v[108:109], v129 offset:3904
    ds_read_b64_tr_b16 v[110:111], v129 offset:3984
    v_mfma_f32_32x32x16_bf16 v[32:47], v[120:123], a[116:119], v[32:47]
    ds_read_b64_tr_b16 v[164:165], v131 offset:3840
    ds_read_b64_tr_b16 v[166:167], v131 offset:3920
    s_waitcnt lgkmcnt(6)
    v_mfma_f32_32x32x16_bf16 v[16:31], v[92:95], a[120:123], v[16:31]
    ds_read_b64_tr_b16 v[116:117], v128 offset:0
    ds_read_b64_tr_b16 v[118:119], v128 offset:80
    ds_read_b64_tr_b16 v[120:121], v128 offset:64
    v_mfma_f32_32x32x16_bf16 v[32:47], v[96:99], a[120:123], v[32:47]
    ds_read_b64_tr_b16 v[122:123], v128 offset:144
    ds_read_b64_tr_b16 v[168:169], v130 offset:0
    ds_read_b64_tr_b16 v[170:171], v130 offset:80
    s_add_u32 m0, s15, 1024
    s_nop 0
    buffer_load_dwordx4 v153, s[16:19], s76 offen lds
    s_waitcnt lgkmcnt(6)
    v_mfma_f32_4x4x4_16b_bf16 v[76:79], v[160:161], v[84:85], v[76:79]
    v_mfma_f32_4x4x4_16b_bf16 v[80:83], v[162:163], v[84:85], v[80:83]
    ds_read_b64_tr_b16 v[92:93], v128 offset:1280
    v_mfma_f32_4x4x4_16b_bf16 v[76:79], v[164:165], v[84:85], v[76:79]
    v_mfma_f32_4x4x4_16b_bf16 v[80:83], v[166:167], v[84:85], v[80:83]
    v_mfma_f32_32x32x16_bf16 v[16:31], v[104:107], a[124:127], v[16:31]
    ds_read_b64_tr_b16 v[94:95], v128 offset:1360
    ds_read_b64_tr_b16 v[96:97], v128 offset:1344
    ds_read_b64_tr_b16 v[98:99], v128 offset:1424
    v_mfma_f32_32x32x16_bf16 v[32:47], v[108:111], a[124:127], v[32:47]
    ds_read_b64_tr_b16 v[160:161], v130 offset:1280
    ds_read_b64_tr_b16 v[162:163], v130 offset:1360
    s_waitcnt lgkmcnt(6)
    v_mfma_f32_32x32x16_bf16 v[16:31], v[116:119], a[128:131], v[16:31]
    ds_read_b64_tr_b16 v[104:105], v128 offset:2560
    ds_read_b64_tr_b16 v[106:107], v128 offset:2640
    ds_read_b64_tr_b16 v[108:109], v128 offset:2624
    v_mfma_f32_32x32x16_bf16 v[32:47], v[120:123], a[128:131], v[32:47]
    ds_read_b64_tr_b16 v[110:111], v128 offset:2704
    ds_read_b64_tr_b16 v[164:165], v130 offset:2560
    ds_read_b64_tr_b16 v[166:167], v130 offset:2640
    s_add_u32 m0, s15, 2048
    s_nop 0
    buffer_load_dwordx4 v154, s[16:19], s76 offen lds
    v_add_u32 v129, s13, v132
    v_add_u32 v131, s13, v133
    s_add_u32 s13, s13, 5120
    s_cmp_eq_u32 s13, 51200
    s_cselect_b32 s13, 0, s13
    s_waitcnt lgkmcnt(6)
    v_mfma_f32_4x4x4_16b_bf16 v[76:79], v[168:169], v[84:85], v[76:79]
    v_mfma_f32_4x4x4_16b_bf16 v[80:83], v[170:171], v[84:85], v[80:83]
    ds_read_b64_tr_b16 v[116:117], v128 offset:3840
    v_mfma_f32_4x4x4_16b_bf16 v[76:79], v[160:161], v[84:85], v[76:79]
    v_mfma_f32_4x4x4_16b_bf16 v[80:83], v[162:163], v[84:85], v[80:83]
    v_mfma_f32_32x32x16_bf16 v[16:31], v[92:95], a[132:135], v[16:31]
    ds_read_b64_tr_b16 v[118:119], v128 offset:3920
    ds_read_b64_tr_b16 v[120:121], v128 offset:3904
    ds_read_b64_tr_b16 v[122:123], v128 offset:3984
    v_mfma_f32_32x32x16_bf16 v[32:47], v[96:99], a[132:135], v[32:47]
    ds_read_b64_tr_b16 v[168:169], v130 offset:3840
    ds_read_b64_tr_b16 v[170:171], v130 offset:3920
    s_cmp_ge_u32 s22, 108
    s_cbranch_scc1 L_nomoeld4
    s_nop 0
    s_and_b32 s62, s22, 3
    s_add_u32 s62, s62, 4
    s_cmp_ge_u32 s62, 5
    s_cselect_b32 s63, 5, 0
    s_sub_u32 s65, s62, s63
    s_mul_i32 s63, s3, 5
    s_add_u32 s65, s65, s63
    s_mul_i32 s64, s65, 110592
    s_lshl_b32 s62, s22, 5
    s_add_u32 s64, s64, s62
    s_lshl_b32 s63, s65, 10
    s_add_u32 m0, s63, 102400
    s_mul_i32 s62, s22, 20480
    buffer_load_dwordx4 v134, s[24:27], s64 offen lds
    s_add_u32 m0, s63, 123008
    v_cmp_gt_u32 vcc, 160, v0
    buffer_load_dwordx4 v134, s[28:31], s64 offen lds
    s_and_saveexec_b64 s[68:69], vcc
    s_cbranch_execz L_nomoeld4_x
    s_add_u32 s63, s62, 15360
    buffer_load_dwordx2 a[184:185], v135, s[32:35], s63 offen
    s_add_u32 s63, s62, 16640
    buffer_load_dwordx2 a[186:187], v135, s[32:35], s63 offen
    s_add_u32 s63, s62, 17920
    buffer_load_dwordx2 a[188:189], v135, s[32:35], s63 offen
    s_add_u32 s63, s62, 19200
    buffer_load_dwordx2 a[190:191], v135, s[32:35], s63 offen
L_nomoeld4_x:
    s_mov_b64 exec, -1
L_nomoeld4:
    s_waitcnt lgkmcnt(6)
    v_mfma_f32_32x32x16_bf16 v[16:31], v[104:107], a[136:139], v[16:31]
    ds_read_b64_tr_b16 v[92:93], v129 offset:0
    ds_read_b64_tr_b16 v[94:95], v129 offset:80
    ds_read_b64_tr_b16 v[96:97], v129 offset:64
    v_mfma_f32_32x32x16_bf16 v[32:47], v[108:111], a[136:139], v[32:47]
    ds_read_b64_tr_b16 v[98:99], v129 offset:144
    ds_read_b64_tr_b16 v[160:161], v131 offset:0
    ds_read_b64_tr_b16 v[162:163], v131 offset:80
    s_add_u32 m0, s15, 3072
    s_nop 0
    buffer_load_dwordx4 v155, s[16:19], s76 offen lds
    s_waitcnt lgkmcnt(6)
    v_mfma_f32_4x4x4_16b_bf16 v[76:79], v[164:165], v[84:85], v[76:79]
    v_mfma_f32_4x4x4_16b_bf16 v[80:83], v[166:167], v[84:85], v[80:83]
    ds_read_b64_tr_b16 v[104:105], v129 offset:1280
    v_mfma_f32_4x4x4_16b_bf16 v[76:79], v[168:169], v[84:85], v[76:79]
    v_mfma_f32_4x4x4_16b_bf16 v[80:83], v[170:171], v[84:85], v[80:83]
    v_mfma_f32_32x32x16_bf16 v[16:31], v[116:119], a[140:143], v[16:31]
    ds_read_b64_tr_b16 v[106:107], v129 offset:1360
    ds_read_b64_tr_b16 v[108:109], v129 offset:1344
    ds_read_b64_tr_b16 v[110:111], v129 offset:1424
    v_mfma_f32_32x32x16_bf16 v[32:47], v[120:123], a[140:143], v[32:47]
    ds_read_b64_tr_b16 v[164:165], v131 offset:1280
    ds_read_b64_tr_b16 v[166:167], v131 offset:1360
    s_waitcnt lgkmcnt(6)
    v_mfma_f32_32x32x16_bf16 v[16:31], v[92:95], a[144:147], v[16:31]
    ds_read_b64_tr_b16 v[116:117], v129 offset:2560
    ds_read_b64_tr_b16 v[118:119], v129 offset:2640
    ds_read_b64_tr_b16 v[120:121], v129 offset:2624
    v_mfma_f32_32x32x16_bf16 v[32:47], v[96:99], a[144:147], v[32:47]
    ds_read_b64_tr_b16 v[122:123], v129 offset:2704
    ds_read_b64_tr_b16 v[168:169], v131 offset:2560
    ds_read_b64_tr_b16 v[170:171], v131 offset:2640
    s_add_u32 m0, s15, 4096
    s_nop 0
    buffer_load_dwordx4 v156, s[16:19], s76 offen lds
    s_add_u32 s62, s51, 0
    s_lshl_b32 s62, s62, 7
    v_mov_b32 v238, s62
    v_cmp_eq_u32 vcc, 1, v1
    s_nop 1
    v_cndmask_b32 v238, v238, 0, vcc
    v_lshlrev_b32 v240, 6, v1
    s_mov_b32 exec_lo, 15
    s_mov_b32 exec_hi, 0
    buffer_load_dword v241, v240, s[40:43], 0 offen sc1
    s_mov_b32 exec_lo, 3
    buffer_load_dword v239, v238, s[44:47], 0 offen sc1
    s_mov_b64 exec, -1
    s_waitcnt lgkmcnt(6)
    v_mfma_f32_4x4x4_16b_bf16 v[76:79], v[160:161], v[84:85], v[76:79]
    v_mfma_f32_4x4x4_16b_bf16 v[80:83], v[162:163], v[84:85], v[80:83]
    ds_read_b64_tr_b16 v[92:93], v129 offset:3840
    v_mfma_f32_4x4x4_16b_bf16 v[76:79], v[164:165], v[84:85], v[76:79]
    v_mfma_f32_4x4x4_16b_bf16 v[80:83], v[166:167], v[84:85], v[80:83]
    v_mfma_f32_32x32x16_bf16 v[16:31], v[104:107], a[148:151], v[16:31]
    ds_read_b64_tr_b16 v[94:95], v129 offset:3920
    ds_read_b64_tr_b16 v[96:97], v129 offset:3904
    ds_read_b64_tr_b16 v[98:99], v129 offset:3984
    v_mfma_f32_32x32x16_bf16 v[32:47], v[108:111], a[148:151], v[32:47]
    ds_read_b64_tr_b16 v[160:161], v131 offset:3840
    ds_read_b64_tr_b16 v[162:163], v131 offset:3920
    s_waitcnt lgkmcnt(6)
    v_mfma_f32_32x32x16_bf16 v[16:31], v[116:119], a[152:155], v[16:31]
    v_mfma_f32_32x32x16_bf16 v[32:47], v[120:123], a[152:155], v[32:47]
    s_waitcnt lgkmcnt(0)
    v_mfma_f32_4x4x4_16b_bf16 v[76:79], v[168:169], v[84:85], v[76:79]
    v_mfma_f32_4x4x4_16b_bf16 v[80:83], v[170:171], v[84:85], v[80:83]
    s_nop 0
    v_mfma_f32_4x4x4_16b_bf16 v[76:79], v[160:161], v[84:85], v[76:79]
    v_mfma_f32_4x4x4_16b_bf16 v[80:83], v[162:163], v[84:85], v[80:83]
    v_mfma_f32_32x32x16_bf16 v[16:31], v[92:95], a[156:159], v[16:31]
    v_mfma_f32_32x32x16_bf16 v[32:47], v[96:99], a[156:159], v[32:47]
    s_mov_b32 exec_lo, 3
    s_mov_b32 exec_hi, 0
    s_mov_b32 s74, 0
    s_waitcnt vmcnt(0)
    v_cmp_gt_u32 vcc, 16, v239
    s_cbranch_vccz L_poll_kv_out
L_poll_kv:
    buffer_load_dword v239, v238, s[44:47], 0 offen sc1
    s_add_u32 s74, s74, 1
    s_cmp_gt_u32 s74, 200000
    s_cbranch_scc1 L_poll_kv_out
    s_waitcnt vmcnt(0)
    v_cmp_gt_u32 vcc, 16, v239
    s_cbranch_vccnz L_poll_kv
L_poll_kv_out:
    s_waitcnt vmcnt(0)
    s_mov_b64 exec, -1
    s_mov_b32 exec_lo, 15
    s_mov_b32 exec_hi, 0
    v_cmp_gt_u32 vcc, 64, v241
    s_mov_b64 exec, -1
    s_cbranch_vccz L_rmaxok
    v_lshlrev_b32 v9, 6, v1
    s_mov_b32 exec_lo, 15
    s_mov_b32 exec_hi, 0
    s_mov_b32 s74, 0
L_poll_rmax:
    buffer_load_dword v10, v9, s[40:43], 0 offen sc1
    s_add_u32 s74, s74, 1
    s_cmp_gt_u32 s74, 200000
    s_cbranch_scc1 L_poll_rmax_out
    s_waitcnt vmcnt(0)
    v_cmp_gt_u32 vcc, 64, v10
    s_cbranch_vccnz L_poll_rmax
L_poll_rmax_out:
    s_waitcnt vmcnt(0)
    s_mov_b64 exec, -1
    s_nop 0
L_rmaxok:
    s_mul_i32 s78, s51, 108544
    s_add_u32 s78, s78, 65536
    s_add_u32 s79, s78, 108544
    s_mov_b32 s75, s78
    s_and_b32 s62, s49, 7
    s_mul_i32 s62, s62, 13568
    s_add_u32 s78, s78, s62
    v_lshlrev_b32 v64, 4, v0
    s_mul_i32 s62, s3, 656
    s_add_u32 s62, s62, 4096
    v_lshl_add_u32 v65, v1, 4, s62
    s_mov_b32 s70, -1
    s_mov_b32 s71, 0x1ff
    v_lshlrev_b32 v66, 5, v1
    v_add_u32 v66, 5275648, v66
    buffer_load_dwordx4 a[0:3], v64, s[44:47], s78 offen sc1
    v_accvgpr_read_b32 v134, a205
    v_accvgpr_read_b32 v68, a211
    v_accvgpr_read_b32 v135, a206
    v_accvgpr_read_b32 v69, a212
    v_accvgpr_read_b32 v136, a207
    v_accvgpr_read_b32 v70, a213
    v_add_f32 v76, v76, v80
    v_add_f32 v77, v77, v81
    v_add_f32 v78, v78, v82
    s_mov_b64 exec, s[70:71]
    buffer_load_dwordx4 a[64:67], v65, s[44:47], s78 offen sc1
    s_mov_b64 exec, -1
    s_add_u32 s78, s78, 6784
    s_cmp_eq_u32 s78, s79
    s_cselect_b32 s78, s75, s78
    v_add_f32 v79, v79, v83
    v_mov_b32 v80, v76
    v_mov_b32 v81, v77
    v_mov_b32 v82, v78
    v_mov_b32 v83, v79
    v_permlane32_swap_b32 v76, v80
    v_permlane32_swap_b32 v77, v81
    v_permlane32_swap_b32 v78, v82
    v_permlane32_swap_b32 v79, v83
    buffer_load_dwordx4 a[4:7], v64, s[44:47], s78 offen sc1
    v_add_f32 v76, v76, v80
    v_add_f32 v77, v77, v81
    v_add_f32 v78, v78, v82
    v_add_f32 v79, v79, v83
    s_lshl_b32 s62, s3, 7
    s_add_u32 s62, s62, 150656
    v_lshl_add_u32 v9, v1, 2, s62
    s_mov_b32 exec_lo, 0x11111111
    s_mov_b32 exec_hi, 0
    ds_write_b128 v9, v[76:79]
    s_mov_b64 exec, -1
    s_mov_b64 exec, s[70:71]
    buffer_load_dwordx4 a[68:71], v65, s[44:47], s78 offen sc1
    s_mov_b64 exec, -1
    s_add_u32 s78, s78, 6784
    s_cmp_eq_u32 s78, s79
    s_cselect_b32 s78, s75, s78
    s_waitcnt lgkmcnt(0)
    s_barrier
    v_lshlrev_b32 v9, 4, v3
    v_add_u32 v9, 150656, v9
    ds_read_b128 v[160:163], v9 offset:0
    ds_read_b128 v[164:167], v9 offset:32
    ds_read_b128 v[168:171], v9 offset:64
    buffer_load_dwordx4 a[8:11], v64, s[44:47], s78 offen sc1
    ds_read_b128 v[172:175], v9 offset:96
    ds_read_b128 v[176:179], v9 offset:128
    s_waitcnt lgkmcnt(4)
    v_pk_fma_f32 v[16:17], v[160:161], v[86:87], v[16:17] op_sel_hi:[1,0,1]
    v_pk_fma_f32 v[18:19], v[162:163], v[86:87], v[18:19] op_sel_hi:[1,0,1]
    v_pk_mul_f32 v[16:17], v[16:17], v[88:89] op_sel_hi:[1,0]
    v_pk_mul_f32 v[18:19], v[18:19], v[88:89] op_sel_hi:[1,0]
    s_waitcnt lgkmcnt(3)
    v_pk_fma_f32 v[20:21], v[164:165], v[86:87], v[20:21] op_sel_hi:[1,0,1]
    s_mov_b64 exec, s[70:71]
    buffer_load_dwordx4 a[72:75], v65, s[44:47], s78 offen sc1
    s_mov_b64 exec, -1
    s_add_u32 s78, s78, 6784
    s_cmp_eq_u32 s78, s79
    s_cselect_b32 s78, s75, s78
    v_pk_fma_f32 v[22:23], v[166:167], v[86:87], v[22:23] op_sel_hi:[1,0,1]
    v_pk_mul_f32 v[20:21], v[20:21], v[88:89] op_sel_hi:[1,0]
    v_pk_mul_f32 v[22:23], v[22:23], v[88:89] op_sel_hi:[1,0]
    s_waitcnt lgkmcnt(2)
    v_pk_fma_f32 v[24:25], v[168:169], v[86:87], v[24:25] op_sel_hi:[1,0,1]
    v_pk_fma_f32 v[26:27], v[170:171], v[86:87], v[26:27] op_sel_hi:[1,0,1]
    v_pk_mul_f32 v[24:25], v[24:25], v[88:89] op_sel_hi:[1,0]
    v_pk_mul_f32 v[26:27], v[26:27], v[88:89] op_sel_hi:[1,0]
    s_waitcnt lgkmcnt(1)
    buffer_load_dwordx4 a[12:15], v64, s[44:47], s78 offen sc1
    v_pk_fma_f32 v[28:29], v[172:173], v[86:87], v[28:29] op_sel_hi:[1,0,1]
    v_pk_fma_f32 v[30:31], v[174:175], v[86:87], v[30:31] op_sel_hi:[1,0,1]
    v_pk_mul_f32 v[28:29], v[28:29], v[88:89] op_sel_hi:[1,0]
    v_pk_mul_f32 v[30:31], v[30:31], v[88:89] op_sel_hi:[1,0]
    s_waitcnt lgkmcnt(0)
    v_pk_fma_f32 v[32:33], v[176:177], v[86:87], v[32:33] op_sel_hi:[1,0,1]
    v_pk_fma_f32 v[34:35], v[178:179], v[86:87], v[34:35] op_sel_hi:[1,0,1]
    v_pk_mul_f32 v[32:33], v[32:33], v[88:89] op_sel_hi:[1,0]
    v_pk_mul_f32 v[34:35], v[34:35], v[88:89] op_sel_hi:[1,0]
    s_mov_b64 exec, s[70:71]
    buffer_load_dwordx4 a[76:79], v65, s[44:47], s78 offen sc1
    s_mov_b64 exec, -1
    s_add_u32 s78, s78, 6784
    s_cmp_eq_u32 s78, s79
    s_cselect_b32 s78, s75, s78
    v_cvt_pk_bf16_f32 v244, v16, v17
    v_cvt_pk_bf16_f32 v245, v18, v19
    v_cvt_pk_bf16_f32 v246, v20, v21
    v_cvt_pk_bf16_f32 v247, v22, v23
    v_cvt_pk_bf16_f32 v248, v24, v25
    v_cvt_pk_bf16_f32 v249, v26, v27
    v_cvt_pk_bf16_f32 v250, v28, v29
    v_cvt_pk_bf16_f32 v251, v30, v31
    v_cvt_pk_bf16_f32 v252, v32, v33
    v_cvt_pk_bf16_f32 v253, v34, v35
    buffer_load_dwordx4 v[16:19], v134, s[4:7], s85 offen
    v_mfma_f32_32x32x16_bf16 v[92:107], v[140:143], v[244:247], 0
    v_mfma_f32_32x32x16_bf16 v[108:123], v[146:149], v[248:251], 0
    v_mfma_f32_32x32x8_bf16 v[92:107], v[144:145], v[248:249], v[92:107]
    v_mfma_f32_32x32x8_bf16 v[108:123], v[150:151], v[252:253], v[108:123]
    v_accvgpr_read_b32 v56, a196
    s_lshl_b32 s62, s12, 3
    s_add_u32 s81, s62, 5242880
    v_lshlrev_b32 v67, 3, v68
    buffer_load_dwordx2 v[28:29], v67, s[44:47], s81 offen sc1
    v_accvgpr_read_b32 v57, a197
    v_accvgpr_read_b32 v58, a198
    v_accvgpr_read_b32 v59, a199
    v_mov_b32 v124, 0x3fb8aa3b
    v_mov_b32 v126, 0xbfb8aa3b
    v_mov_b32 v230, 0
    buffer_load_dwordx4 v[20:23], v135, s[4:7], s85 offen
    v_mov_b32 v231, 0
    v_mov_b32 v242, 0
    v_mov_b32 v243, 0
    v_max3_f32 v200, v92, v93, v94
    v_min3_f32 v201, v92, v93, v94
    v_lshlrev_b32 v67, 3, v69
    buffer_load_dwordx2 v[30:31], v67, s[44:47], s81 offen sc1
    v_max3_f32 v200, v200, v95, v96
    v_min3_f32 v201, v201, v95, v96
    v_max3_f32 v200, v200, v97, v98
    v_min3_f32 v201, v201, v97, v98
    v_max3_f32 v200, v200, v99, v100
    v_min3_f32 v201, v201, v99, v100
    buffer_load_dwordx4 v[24:27], v136, s[4:7], s85 offen
    v_max_f32 v200, v200, v101
    v_min_f32 v201, v201, v101
    v_sub_f32 v201, 0, v201
    v_max3_f32 v204, v108, v109, v110
    v_min3_f32 v205, v108, v109, v110
    v_max3_f32 v204, v204, v111, v112
    v_lshlrev_b32 v67, 3, v70
    buffer_load_dwordx2 v[32:33], v67, s[44:47], s81 offen sc1
    v_min3_f32 v205, v205, v111, v112
    v_max3_f32 v204, v204, v113, v114
    v_min3_f32 v205, v205, v113, v114
    v_max3_f32 v204, v204, v115, v116
    v_min3_f32 v205, v205, v115, v116
    buffer_load_dwordx4 a[16:19], v64, s[44:47], s78 offen sc1
    v_max_f32 v204, v204, v117
    v_min_f32 v205, v205, v117
    v_sub_f32 v205, 0, v205
    v_permlane32_swap_b32 v200, v201
    s_nop 0
    v_permlane32_swap_b32 v204, v205
    v_max_f32 v200, v200, v201
    s_mov_b64 exec, s[70:71]
    buffer_load_dwordx4 a[80:83], v65, s[44:47], s78 offen sc1
    s_mov_b64 exec, -1
    s_add_u32 s78, s78, 6784
    s_cmp_eq_u32 s78, s79
    s_cselect_b32 s78, s75, s78
    v_max_f32 v204, v204, v205
    v_mov_b32 v201, v200
    v_mov_b32 v205, v204
    s_nop 0
    v_permlane32_swap_b32 v200, v201
    v_permlane32_swap_b32 v204, v205
    v_mul_f32 v202, v201, v126
    buffer_load_dwordx4 a[20:23], v64, s[44:47], s78 offen sc1
    v_mul_f32 v200, v200, v126
    v_mul_f32 v206, v205, v126
    v_mul_f32 v204, v204, v126
    v_pk_fma_f32 v[160:161], v[92:93], v[124:125], v[200:201] op_sel_hi:[1,0,0]
    v_pk_fma_f32 v[170:171], v[92:93], v[126:127], v[202:203] op_sel_hi:[1,0,0]
    s_mov_b64 exec, s[70:71]
    buffer_load_dwordx4 a[84:87], v65, s[44:47], s78 offen sc1
    s_mov_b64 exec, -1
    s_add_u32 s78, s78, 6784
    s_cmp_eq_u32 s78, s79
    s_cselect_b32 s78, s75, s78
    v_pk_fma_f32 v[162:163], v[94:95], v[124:125], v[200:201] op_sel_hi:[1,0,0]
    v_pk_fma_f32 v[172:173], v[94:95], v[126:127], v[202:203] op_sel_hi:[1,0,0]
    v_pk_fma_f32 v[164:165], v[96:97], v[124:125], v[200:201] op_sel_hi:[1,0,0]
    v_pk_fma_f32 v[174:175], v[96:97], v[126:127], v[202:203] op_sel_hi:[1,0,0]
    v_pk_fma_f32 v[166:167], v[98:99], v[124:125], v[200:201] op_sel_hi:[1,0,0]
    v_pk_fma_f32 v[176:177], v[98:99], v[126:127], v[202:203] op_sel_hi:[1,0,0]
    buffer_load_dwordx4 a[24:27], v64, s[44:47], s78 offen sc1
    v_pk_fma_f32 v[168:169], v[100:101], v[124:125], v[200:201] op_sel_hi:[1,0,0]
    v_pk_fma_f32 v[178:179], v[100:101], v[126:127], v[202:203] op_sel_hi:[1,0,0]
    v_pk_fma_f32 v[180:181], v[108:109], v[124:125], v[204:205] op_sel_hi:[1,0,0]
    v_pk_fma_f32 v[190:191], v[108:109], v[126:127], v[206:207] op_sel_hi:[1,0,0]
    v_pk_fma_f32 v[182:183], v[110:111], v[124:125], v[204:205] op_sel_hi:[1,0,0]
    s_mov_b64 exec, s[70:71]
    buffer_load_dwordx4 a[88:91], v65, s[44:47], s78 offen sc1
    s_mov_b64 exec, -1
    s_add_u32 s78, s78, 6784
    s_cmp_eq_u32 s78, s79
    s_cselect_b32 s78, s75, s78
    v_pk_fma_f32 v[192:193], v[110:111], v[126:127], v[206:207] op_sel_hi:[1,0,0]
    v_pk_fma_f32 v[184:185], v[112:113], v[124:125], v[204:205] op_sel_hi:[1,0,0]
    v_pk_fma_f32 v[194:195], v[112:113], v[126:127], v[206:207] op_sel_hi:[1,0,0]
    v_pk_fma_f32 v[186:187], v[114:115], v[124:125], v[204:205] op_sel_hi:[1,0,0]
    v_pk_fma_f32 v[196:197], v[114:115], v[126:127], v[206:207] op_sel_hi:[1,0,0]
    v_pk_fma_f32 v[188:189], v[116:117], v[124:125], v[204:205] op_sel_hi:[1,0,0]
    buffer_load_dwordx4 a[28:31], v64, s[44:47], s78 offen sc1
    v_pk_fma_f32 v[198:199], v[116:117], v[126:127], v[206:207] op_sel_hi:[1,0,0]
    v_exp_f32 v160, v160
    v_exp_f32 v161, v161
    v_exp_f32 v162, v162
    v_exp_f32 v163, v163
    v_exp_f32 v164, v164
    s_mov_b64 exec, s[70:71]
    buffer_load_dwordx4 a[92:95], v65, s[44:47], s78 offen sc1
    s_mov_b64 exec, -1
    s_add_u32 s78, s78, 6784
    s_cmp_eq_u32 s78, s79
    s_cselect_b32 s78, s75, s78
    v_exp_f32 v165, v165
    v_exp_f32 v166, v166
    v_exp_f32 v167, v167
    v_exp_f32 v168, v168
    v_exp_f32 v169, v169
    buffer_load_dwordx4 a[32:35], v64, s[44:47], s78 offen sc1
    v_exp_f32 v170, v170
    v_exp_f32 v171, v171
    v_exp_f32 v172, v172
    v_exp_f32 v173, v173
    v_exp_f32 v174, v174
    v_exp_f32 v175, v175
    s_mov_b64 exec, s[70:71]
    buffer_load_dwordx4 a[96:99], v65, s[44:47], s78 offen sc1
    s_mov_b64 exec, -1
    s_add_u32 s78, s78, 6784
    s_cmp_eq_u32 s78, s79
    s_cselect_b32 s78, s75, s78
    v_exp_f32 v176, v176
    v_exp_f32 v177, v177
    v_exp_f32 v178, v178
    v_exp_f32 v179, v179
    v_exp_f32 v180, v180
    v_exp_f32 v181, v181
    buffer_load_dwordx4 a[36:39], v64, s[44:47], s78 offen sc1
    v_exp_f32 v182, v182
    v_exp_f32 v183, v183
    v_exp_f32 v184, v184
    v_exp_f32 v185, v185
    v_exp_f32 v186, v186
    s_mov_b64 exec, s[70:71]
    buffer_load_dwordx4 a[100:103], v65, s[44:47], s78 offen sc1
    s_mov_b64 exec, -1
    s_add_u32 s78, s78, 6784
    s_cmp_eq_u32 s78, s79
    s_cselect_b32 s78, s75, s78
    v_exp_f32 v187, v187
    v_exp_f32 v188, v188
    v_exp_f32 v189, v189
    v_exp_f32 v190, v190
    v_exp_f32 v191, v191
    v_exp_f32 v192, v192
    buffer_load_dwordx4 a[40:43], v64, s[44:47], s78 offen sc1
    v_exp_f32 v193, v193
    v_exp_f32 v194, v194
    v_exp_f32 v195, v195
    v_exp_f32 v196, v196
    v_exp_f32 v197, v197
    s_mov_b64 exec, s[70:71]
    buffer_load_dwordx4 a[104:107], v65, s[44:47], s78 offen sc1
    s_mov_b64 exec, -1
    s_add_u32 s78, s78, 6784
    s_cmp_eq_u32 s78, s79
    s_cselect_b32 s78, s75, s78
    v_exp_f32 v198, v198
    v_exp_f32 v199, v199
    v_pk_add_f32 v[208:209], v[160:161], v[162:163]
    v_pk_add_f32 v[210:211], v[170:171], v[172:173]
    v_pk_add_f32 v[214:215], v[180:181], v[182:183]
    v_pk_add_f32 v[216:217], v[190:191], v[192:193]
    buffer_load_dwordx4 a[44:47], v64, s[44:47], s78 offen sc1
    v_pk_add_f32 v[208:209], v[208:209], v[164:165]
    v_pk_add_f32 v[210:211], v[210:211], v[174:175]
    v_pk_add_f32 v[214:215], v[214:215], v[184:185]
    v_pk_add_f32 v[216:217], v[216:217], v[194:195]
    v_pk_add_f32 v[208:209], v[208:209], v[166:167]
    v_pk_add_f32 v[210:211], v[210:211], v[176:177]
    s_mov_b64 exec, s[70:71]
    buffer_load_dwordx4 a[108:111], v65, s[44:47], s78 offen sc1
    s_mov_b64 exec, -1
    s_add_u32 s78, s78, 6784
    s_cmp_eq_u32 s78, s79
    s_cselect_b32 s78, s75, s78
    v_pk_add_f32 v[214:215], v[214:215], v[186:187]
    v_pk_add_f32 v[216:217], v[216:217], v[196:197]
    v_pk_add_f32 v[208:209], v[208:209], v[168:169]
    v_pk_add_f32 v[210:211], v[210:211], v[178:179]
    v_pk_add_f32 v[214:215], v[214:215], v[188:189]
    buffer_load_dwordx4 a[48:51], v64, s[44:47], s78 offen sc1
    v_pk_add_f32 v[216:217], v[216:217], v[198:199]
    v_add_f32 v208, v208, v209
    v_add_f32 v209, v210, v211
    v_add_f32 v214, v214, v215
    v_add_f32 v215, v216, v217
    v_permlane32_swap_b32 v208, v209
    s_mov_b64 exec, s[70:71]
    buffer_load_dwordx4 a[112:115], v65, s[44:47], s78 offen sc1
    s_mov_b64 exec, -1
    s_add_u32 s78, s78, 6784
    s_cmp_eq_u32 s78, s79
    s_cselect_b32 s78, s75, s78
    v_permlane32_swap_b32 v214, v215
    v_add_f32 v208, v208, v209
    v_add_f32 v214, v214, v215
    v_mov_b32 v210, v208
    v_mov_b32 v216, v214
    s_nop 0
    v_permlane32_swap_b32 v208, v210
    buffer_load_dwordx4 a[52:55], v64, s[44:47], s78 offen sc1
    v_permlane32_swap_b32 v214, v216
    v_rcp_f32 v208, v208
    v_rcp_f32 v210, v210
    v_rcp_f32 v214, v214
    v_rcp_f32 v216, v216
    s_mov_b64 exec, s[70:71]
    buffer_load_dwordx4 a[116:119], v65, s[44:47], s78 offen sc1
    s_mov_b64 exec, -1
    s_add_u32 s78, s78, 6784
    s_cmp_eq_u32 s78, s79
    s_cselect_b32 s78, s75, s78
    v_pk_mul_f32 v[160:161], v[160:161], v[208:209] op_sel_hi:[1,0]
    v_pk_mul_f32 v[170:171], v[170:171], v[210:211] op_sel_hi:[1,0]
    v_pk_mul_f32 v[162:163], v[162:163], v[208:209] op_sel_hi:[1,0]
    v_pk_mul_f32 v[172:173], v[172:173], v[210:211] op_sel_hi:[1,0]
    v_pk_mul_f32 v[164:165], v[164:165], v[208:209] op_sel_hi:[1,0]
    v_pk_mul_f32 v[174:175], v[174:175], v[210:211] op_sel_hi:[1,0]
    buffer_load_dwordx4 a[56:59], v64, s[44:47], s78 offen sc1
    v_pk_mul_f32 v[166:167], v[166:167], v[208:209] op_sel_hi:[1,0]
    v_pk_mul_f32 v[176:177], v[176:177], v[210:211] op_sel_hi:[1,0]
    v_pk_mul_f32 v[168:169], v[168:169], v[208:209] op_sel_hi:[1,0]
    v_pk_mul_f32 v[178:179], v[178:179], v[210:211] op_sel_hi:[1,0]
    v_cvt_pk_bf16_f32 v220, v160, v161
    s_mov_b64 exec, s[70:71]
    buffer_load_dwordx4 a[120:123], v65, s[44:47], s78 offen sc1
    s_mov_b64 exec, -1
    s_add_u32 s78, s78, 6784
    s_cmp_eq_u32 s78, s79
    s_cselect_b32 s78, s75, s78
    v_cvt_pk_bf16_f32 v221, v162, v163
    v_cvt_pk_bf16_f32 v222, v164, v165
    v_cvt_pk_bf16_f32 v223, v166, v167
    v_cvt_pk_bf16_f32 v224, v168, v169
    v_cvt_pk_bf16_f32 v225, v170, v171
    v_cvt_pk_bf16_f32 v226, v172, v173
    buffer_load_dwordx4 a[60:63], v64, s[44:47], s78 offen sc1
    v_cvt_pk_bf16_f32 v227, v174, v175
    v_cvt_pk_bf16_f32 v228, v176, v177
    v_cvt_pk_bf16_f32 v229, v178, v179
    v_pk_mul_f32 v[180:181], v[180:181], v[214:215] op_sel_hi:[1,0]
    v_pk_mul_f32 v[190:191], v[190:191], v[216:217] op_sel_hi:[1,0]
    v_pk_mul_f32 v[182:183], v[182:183], v[214:215] op_sel_hi:[1,0]
    s_mov_b64 exec, s[70:71]
    buffer_load_dwordx4 a[124:127], v65, s[44:47], s78 offen sc1
    s_mov_b64 exec, -1
    s_add_u32 s78, s78, 6784
    s_cmp_eq_u32 s78, s79
    s_cselect_b32 s78, s75, s78
    v_pk_mul_f32 v[192:193], v[192:193], v[216:217] op_sel_hi:[1,0]
    v_pk_mul_f32 v[184:185], v[184:185], v[214:215] op_sel_hi:[1,0]
    v_pk_mul_f32 v[194:195], v[194:195], v[216:217] op_sel_hi:[1,0]
    v_pk_mul_f32 v[186:187], v[186:187], v[214:215] op_sel_hi:[1,0]
    v_pk_mul_f32 v[196:197], v[196:197], v[216:217] op_sel_hi:[1,0]
    buffer_load_dwordx4 v[48:51], v66, s[44:47], 0 offen sc1
    v_pk_mul_f32 v[188:189], v[188:189], v[214:215] op_sel_hi:[1,0]
    v_pk_mul_f32 v[198:199], v[198:199], v[216:217] op_sel_hi:[1,0]
    v_cvt_pk_bf16_f32 v232, v180, v181
    v_cvt_pk_bf16_f32 v233, v182, v183
    v_cvt_pk_bf16_f32 v234, v184, v185
    v_cvt_pk_bf16_f32 v235, v186, v187
    buffer_load_dwordx4 v[52:55], v66, s[44:47], 0 offen offset:16 sc1
    v_cvt_pk_bf16_f32 v236, v188, v189
    v_cvt_pk_bf16_f32 v237, v190, v191
    v_cvt_pk_bf16_f32 v238, v192, v193
    v_cvt_pk_bf16_f32 v239, v194, v195
    v_cvt_pk_bf16_f32 v240, v196, v197
    v_cvt_pk_bf16_f32 v241, v198, v199
    s_waitcnt vmcnt(26)
    s_add_u32 s65, s3, 0
    s_mul_i32 s15, s65, 5120
    s_mul_i32 s66, s65, 13108
    s_lshr_b32 s66, s66, 16
    s_mul_i32 s66, s66, 153600
    s_mul_i32 s65, s65, 10240
    s_add_u32 s65, s65, s66
    s_add_u32 s76, s65, s14
    s_add_u32 m0, s15, 0
    s_nop 0
    buffer_load_dwordx4 v152, s[16:19], s76 offen lds
    v_rcp_f32 v29, v29
    v_lshlrev_b32 v10, 16, v16
    v_and_b32 v11, 0xffff0000, v16
    v_sub_f32 v12, v10, v28
    v_sub_f32 v13, v11, v28
    v_cvt_pk_bf16_f32 v12, v12, v13
    v_lshlrev_b32 v13, 16, v12
    v_and_b32 v12, 0xffff0000, v12
    v_mul_f32 v13, v13, v29
    v_mul_f32 v12, v12, v29
    v_cvt_pk_bf16_f32 v12, v13, v12
    v_lshlrev_b32 v13, 16, v12
    v_and_b32 v12, 0xffff0000, v12
    v_add_f32 v176, v13, v10
    v_add_f32 v177, v12, v11
    v_lshlrev_b32 v10, 16, v17
    v_and_b32 v11, 0xffff0000, v17
    v_sub_f32 v12, v10, v28
    v_sub_f32 v13, v11, v28
    v_cvt_pk_bf16_f32 v12, v12, v13
    v_lshlrev_b32 v13, 16, v12
    s_add_u32 m0, s15, 1024
    s_nop 0
    buffer_load_dwordx4 v153, s[16:19], s76 offen lds
    v_and_b32 v12, 0xffff0000, v12
    v_mul_f32 v13, v13, v29
    v_mul_f32 v12, v12, v29
    v_cvt_pk_bf16_f32 v12, v13, v12
    v_lshlrev_b32 v13, 16, v12
    v_and_b32 v12, 0xffff0000, v12
    v_add_f32 v178, v13, v10
    v_add_f32 v179, v12, v11
    v_lshlrev_b32 v10, 16, v18
    v_and_b32 v11, 0xffff0000, v18
    v_sub_f32 v12, v10, v28
    v_sub_f32 v13, v11, v28
    v_cvt_pk_bf16_f32 v12, v12, v13
    v_lshlrev_b32 v13, 16, v12
    v_and_b32 v12, 0xffff0000, v12
    v_mul_f32 v13, v13, v29
    v_mul_f32 v12, v12, v29
    v_cvt_pk_bf16_f32 v12, v13, v12
    v_lshlrev_b32 v13, 16, v12
    v_and_b32 v12, 0xffff0000, v12
    v_add_f32 v180, v13, v10
    s_add_u32 m0, s15, 2048
    s_nop 0
    buffer_load_dwordx4 v154, s[16:19], s76 offen lds
    v_add_f32 v181, v12, v11
    v_lshlrev_b32 v10, 16, v19
    v_and_b32 v11, 0xffff0000, v19
    v_sub_f32 v12, v10, v28
    v_sub_f32 v13, v11, v28
    v_cvt_pk_bf16_f32 v12, v12, v13
    v_lshlrev_b32 v13, 16, v12
    v_and_b32 v12, 0xffff0000, v12
    v_mul_f32 v13, v13, v29
    v_mul_f32 v12, v12, v29
    v_cvt_pk_bf16_f32 v12, v13, v12
    v_lshlrev_b32 v13, 16, v12
    v_and_b32 v12, 0xffff0000, v12
    v_add_f32 v182, v13, v10
    v_add_f32 v183, v12, v11
    v_rcp_f32 v31, v31
    v_lshlrev_b32 v10, 16, v20
    v_and_b32 v11, 0xffff0000, v20
    v_sub_f32 v12, v10, v30
    v_sub_f32 v13, v11, v30
    v_cvt_pk_bf16_f32 v12, v12, v13
    v_lshlrev_b32 v13, 16, v12
    s_add_u32 m0, s15, 3072
    s_nop 0
    buffer_load_dwordx4 v155, s[16:19], s76 offen lds
    v_and_b32 v12, 0xffff0000, v12
    v_mul_f32 v13, v13, v31
    v_mul_f32 v12, v12, v31
    v_cvt_pk_bf16_f32 v12, v13, v12
    v_lshlrev_b32 v13, 16, v12
    v_and_b32 v12, 0xffff0000, v12
    v_add_f32 v184, v13, v10
    v_add_f32 v185, v12, v11
    v_lshlrev_b32 v10, 16, v21
    v_and_b32 v11, 0xffff0000, v21
    v_sub_f32 v12, v10, v30
    v_sub_f32 v13, v11, v30
    v_cvt_pk_bf16_f32 v12, v12, v13
    v_lshlrev_b32 v13, 16, v12
    v_and_b32 v12, 0xffff0000, v12
    v_mul_f32 v13, v13, v31
    v_mul_f32 v12, v12, v31
    v_cvt_pk_bf16_f32 v12, v13, v12
    v_lshlrev_b32 v13, 16, v12
    v_and_b32 v12, 0xffff0000, v12
    v_add_f32 v186, v13, v10
    s_add_u32 m0, s15, 4096
    s_nop 0
    buffer_load_dwordx4 v156, s[16:19], s76 offen lds
    v_add_f32 v187, v12, v11
    v_lshlrev_b32 v10, 16, v22
    v_and_b32 v11, 0xffff0000, v22
    v_sub_f32 v12, v10, v30
    v_sub_f32 v13, v11, v30
    v_cvt_pk_bf16_f32 v12, v12, v13
    v_lshlrev_b32 v13, 16, v12
    v_and_b32 v12, 0xffff0000, v12
    v_mul_f32 v13, v13, v31
    v_mul_f32 v12, v12, v31
    v_cvt_pk_bf16_f32 v12, v13, v12
    v_lshlrev_b32 v13, 16, v12
    v_and_b32 v12, 0xffff0000, v12
    v_add_f32 v188, v13, v10
    v_add_f32 v189, v12, v11
    v_lshlrev_b32 v10, 16, v23
    v_and_b32 v11, 0xffff0000, v23
    v_sub_f32 v12, v10, v30
    v_sub_f32 v13, v11, v30
    v_cvt_pk_bf16_f32 v12, v12, v13
    v_lshlrev_b32 v13, 16, v12
    s_add_u32 s65, s3, 4
    s_mul_i32 s15, s65, 5120
    s_mul_i32 s66, s65, 13108
    s_lshr_b32 s66, s66, 16
    s_mul_i32 s66, s66, 153600
    s_mul_i32 s65, s65, 10240
    s_add_u32 s65, s65, s66
    s_add_u32 s76, s65, s14
    s_add_u32 m0, s15, 0
    s_nop 0
    buffer_load_dwordx4 v152, s[16:19], s76 offen lds
    v_and_b32 v12, 0xffff0000, v12
    v_mul_f32 v13, v13, v31
    v_mul_f32 v12, v12, v31
    v_cvt_pk_bf16_f32 v12, v13, v12
    v_lshlrev_b32 v13, 16, v12
    v_and_b32 v12, 0xffff0000, v12
    v_add_f32 v190, v13, v10
    v_add_f32 v191, v12, v11
    v_rcp_f32 v33, v33
    v_lshlrev_b32 v10, 16, v24
    v_and_b32 v11, 0xffff0000, v24
    v_sub_f32 v12, v10, v32
    v_sub_f32 v13, v11, v32
    v_cvt_pk_bf16_f32 v12, v12, v13
    v_lshlrev_b32 v13, 16, v12
    v_and_b32 v12, 0xffff0000, v12
    v_mul_f32 v13, v13, v33
    v_mul_f32 v12, v12, v33
    v_cvt_pk_bf16_f32 v12, v13, v12
    v_lshlrev_b32 v13, 16, v12
    v_and_b32 v12, 0xffff0000, v12
    v_add_f32 v192, v13, v10
    s_add_u32 m0, s15, 1024
    s_nop 0
    buffer_load_dwordx4 v153, s[16:19], s76 offen lds
    v_add_f32 v193, v12, v11
    v_lshlrev_b32 v10, 16, v25
    v_and_b32 v11, 0xffff0000, v25
    v_sub_f32 v12, v10, v32
    v_sub_f32 v13, v11, v32
    v_cvt_pk_bf16_f32 v12, v12, v13
    v_lshlrev_b32 v13, 16, v12
    v_and_b32 v12, 0xffff0000, v12
    v_mul_f32 v13, v13, v33
    v_mul_f32 v12, v12, v33
    v_cvt_pk_bf16_f32 v12, v13, v12
    v_lshlrev_b32 v13, 16, v12
    v_and_b32 v12, 0xffff0000, v12
    v_add_f32 v194, v13, v10
    v_add_f32 v195, v12, v11
    v_lshlrev_b32 v10, 16, v26
    v_and_b32 v11, 0xffff0000, v26
    v_sub_f32 v12, v10, v32
    v_sub_f32 v13, v11, v32
    v_cvt_pk_bf16_f32 v12, v12, v13
    v_lshlrev_b32 v13, 16, v12
    s_add_u32 m0, s15, 2048
    s_nop 0
    buffer_load_dwordx4 v154, s[16:19], s76 offen lds
    v_and_b32 v12, 0xffff0000, v12
    v_mul_f32 v13, v13, v33
    v_mul_f32 v12, v12, v33
    v_cvt_pk_bf16_f32 v12, v13, v12
    v_lshlrev_b32 v13, 16, v12
    v_and_b32 v12, 0xffff0000, v12
    v_add_f32 v196, v13, v10
    v_add_f32 v197, v12, v11
    v_lshlrev_b32 v10, 16, v27
    v_and_b32 v11, 0xffff0000, v27
    v_sub_f32 v12, v10, v32
    v_sub_f32 v13, v11, v32
    v_cvt_pk_bf16_f32 v12, v12, v13
    v_lshlrev_b32 v13, 16, v12
    v_and_b32 v12, 0xffff0000, v12
    v_mul_f32 v13, v13, v33
    v_mul_f32 v12, v12, v33
    v_cvt_pk_bf16_f32 v12, v13, v12
    v_lshlrev_b32 v13, 16, v12
    v_and_b32 v12, 0xffff0000, v12
    v_add_f32 v198, v13, v10
    v_add_f32 v199, v12, v11
    v_accvgpr_read_b32 v137, a208
    v_accvgpr_read_b32 v140, a211
    v_accvgpr_read_b32 v143, a214
    v_accvgpr_read_b32 v138, a209
    v_accvgpr_read_b32 v141, a212
    v_accvgpr_read_b32 v144, a215
    v_accvgpr_read_b32 v139, a210
    v_accvgpr_read_b32 v142, a213
    v_accvgpr_read_b32 v145, a216
    s_waitcnt vmcnt(8)
    s_cmp_ge_u32 s22, 108
    s_cbranch_scc1 L_noxrow
    s_nop 0
    v_cmp_gt_f32 vcc, v50, v48
    s_nop 1
    v_cndmask_b32 v48, v48, v50, vcc
    v_cndmask_b32 v49, v49, v51, vcc
    v_cmp_gt_f32 vcc, v52, v48
    s_nop 1
    v_cndmask_b32 v48, v48, v52, vcc
    v_cndmask_b32 v49, v49, v53, vcc
    v_cmp_gt_f32 vcc, v54, v48
    s_nop 1
    v_cndmask_b32 v48, v48, v54, vcc
    v_cndmask_b32 v49, v49, v55, vcc
    v_mov_b32 v50, v48
    s_nop 1
    v_max_f32_dpp v50, v50, v50 row_shr:1 row_mask:0xf bank_mask:0xf
    s_nop 1
    v_max_f32_dpp v50, v50, v50 row_shr:2 row_mask:0xf bank_mask:0xf
    s_nop 1
    v_max_f32_dpp v50, v50, v50 row_shr:4 row_mask:0xf bank_mask:0xf
    s_nop 1
    v_max_f32_dpp v50, v50, v50 row_shr:8 row_mask:0xf bank_mask:0xf
    s_nop 1
    v_max_f32_dpp v50, v50, v50 row_bcast:15 row_mask:0xa bank_mask:0xf
    s_nop 1
    v_max_f32_dpp v50, v50, v50 row_bcast:31 row_mask:0xc bank_mask:0xf
    s_nop 0
    v_readlane_b32 s23, v50, 63
    s_nop 1
    v_cmp_eq_f32 vcc, s23, v48
    s_nop 0
    s_ff1_i32_b64 s62, vcc
    s_max_i32 s62, s62, 0
    v_readlane_b32 s83, v49, s62
    s_nop 0
    s_and_b32 s83, s83, 2047
    v_mul_u32_u24 v9, 20, v1
    s_mul_i32 s63, s83, 1280
    buffer_load_dwordx4 v[60:63], v9, s[4:7], s63 offen
    buffer_load_dword v64, v9, s[4:7], s63 offen offset:16
    s_lshl_b32 s63, s83, 3
    s_add_u32 s63, s63, 5242880
    v_mov_b32 v9, 0
    buffer_load_dwordx2 v[66:67], v9, s[44:47], s63 offen sc1
L_noxrow:
    s_add_u32 m0, s15, 3072
    s_nop 0
    buffer_load_dwordx4 v155, s[16:19], s76 offen lds
    v_accvgpr_read_b32 v16, a0
    v_accvgpr_read_b32 v17, a1
    v_accvgpr_read_b32 v18, a2
    v_accvgpr_read_b32 v19, a3
    v_accvgpr_read_b32 v24, a4
    v_accvgpr_read_b32 v25, a5
    v_accvgpr_read_b32 v26, a6
    v_accvgpr_read_b32 v27, a7
    v_pk_add_f32 v[16:17], v[16:17], v[24:25]
    v_pk_add_f32 v[18:19], v[18:19], v[26:27]
    v_accvgpr_read_b32 v20, a8
    v_accvgpr_read_b32 v21, a9
    v_accvgpr_read_b32 v22, a10
    v_accvgpr_read_b32 v23, a11
    v_pk_add_f32 v[16:17], v[16:17], v[20:21]
    v_pk_add_f32 v[18:19], v[18:19], v[22:23]
    v_accvgpr_read_b32 v24, a12
    v_accvgpr_read_b32 v25, a13
    v_accvgpr_read_b32 v26, a14
    v_accvgpr_read_b32 v27, a15
    v_pk_add_f32 v[16:17], v[16:17], v[24:25]
    v_pk_add_f32 v[18:19], v[18:19], v[26:27]
    v_accvgpr_read_b32 v20, a16
    v_accvgpr_read_b32 v21, a17
    v_accvgpr_read_b32 v22, a18
    v_accvgpr_read_b32 v23, a19
    s_add_u32 m0, s15, 4096
    s_nop 0
    buffer_load_dwordx4 v156, s[16:19], s76 offen lds
    v_pk_add_f32 v[16:17], v[16:17], v[20:21]
    v_pk_add_f32 v[18:19], v[18:19], v[22:23]
    v_accvgpr_read_b32 v24, a20
    v_accvgpr_read_b32 v25, a21
    v_accvgpr_read_b32 v26, a22
    v_accvgpr_read_b32 v27, a23
    v_pk_add_f32 v[16:17], v[16:17], v[24:25]
    v_pk_add_f32 v[18:19], v[18:19], v[26:27]
    v_accvgpr_read_b32 v20, a24
    v_accvgpr_read_b32 v21, a25
    v_accvgpr_read_b32 v22, a26
    v_accvgpr_read_b32 v23, a27
    v_pk_add_f32 v[16:17], v[16:17], v[20:21]
    v_pk_add_f32 v[18:19], v[18:19], v[22:23]
    v_accvgpr_read_b32 v24, a28
    v_accvgpr_read_b32 v25, a29
    v_accvgpr_read_b32 v26, a30
    v_accvgpr_read_b32 v27, a31
    v_pk_add_f32 v[16:17], v[16:17], v[24:25]
    v_pk_add_f32 v[18:19], v[18:19], v[26:27]
    v_accvgpr_read_b32 v20, a32
    v_accvgpr_read_b32 v21, a33
    v_accvgpr_read_b32 v22, a34
    v_accvgpr_read_b32 v23, a35
    v_pk_add_f32 v[16:17], v[16:17], v[20:21]
    v_pk_add_f32 v[18:19], v[18:19], v[22:23]
    v_accvgpr_read_b32 v24, a36
    s_add_u32 s65, s3, 8
    s_mul_i32 s15, s65, 5120
    s_mul_i32 s66, s65, 13108
    s_lshr_b32 s66, s66, 16
    s_mul_i32 s66, s66, 153600
    s_mul_i32 s65, s65, 10240
    s_add_u32 s65, s65, s66
    s_add_u32 s76, s65, s14
    s_add_u32 m0, s15, 0
    s_nop 0
    buffer_load_dwordx4 v152, s[16:19], s76 offen lds
    v_accvgpr_read_b32 v25, a37
    v_accvgpr_read_b32 v26, a38
    v_accvgpr_read_b32 v27, a39
    v_pk_add_f32 v[16:17], v[16:17], v[24:25]
    v_pk_add_f32 v[18:19], v[18:19], v[26:27]
    v_accvgpr_read_b32 v20, a40
    v_accvgpr_read_b32 v21, a41
    v_accvgpr_read_b32 v22, a42
    v_accvgpr_read_b32 v23, a43
    v_pk_add_f32 v[16:17], v[16:17], v[20:21]
    v_pk_add_f32 v[18:19], v[18:19], v[22:23]
    v_accvgpr_read_b32 v24, a44
    v_accvgpr_read_b32 v25, a45
    v_accvgpr_read_b32 v26, a46
    v_accvgpr_read_b32 v27, a47
    v_pk_add_f32 v[16:17], v[16:17], v[24:25]
    v_pk_add_f32 v[18:19], v[18:19], v[26:27]
    v_accvgpr_read_b32 v20, a48
    v_accvgpr_read_b32 v21, a49
    v_accvgpr_read_b32 v22, a50
    v_accvgpr_read_b32 v23, a51
    v_pk_add_f32 v[16:17], v[16:17], v[20:21]
    v_pk_add_f32 v[18:19], v[18:19], v[22:23]
    v_accvgpr_read_b32 v24, a52
    v_accvgpr_read_b32 v25, a53
    v_accvgpr_read_b32 v26, a54
    v_accvgpr_read_b32 v27, a55
    s_add_u32 m0, s15, 1024
    s_nop 0
    buffer_load_dwordx4 v153, s[16:19], s76 offen lds
    v_pk_add_f32 v[16:17], v[16:17], v[24:25]
    v_pk_add_f32 v[18:19], v[18:19], v[26:27]
    v_accvgpr_read_b32 v20, a56
    v_accvgpr_read_b32 v21, a57
    v_accvgpr_read_b32 v22, a58
    v_accvgpr_read_b32 v23, a59
    v_pk_add_f32 v[16:17], v[16:17], v[20:21]
    v_pk_add_f32 v[18:19], v[18:19], v[22:23]
    v_accvgpr_read_b32 v24, a60
    v_accvgpr_read_b32 v25, a61
    v_accvgpr_read_b32 v26, a62
    v_accvgpr_read_b32 v27, a63
    v_pk_add_f32 v[16:17], v[16:17], v[24:25]
    v_pk_add_f32 v[18:19], v[18:19], v[26:27]
    v_accvgpr_read_b32 v92, a64
    v_accvgpr_read_b32 v93, a65
    v_accvgpr_read_b32 v94, a66
    v_accvgpr_read_b32 v95, a67
    v_accvgpr_read_b32 v100, a68
    v_accvgpr_read_b32 v101, a69
    v_accvgpr_read_b32 v102, a70
    v_accvgpr_read_b32 v103, a71
    v_pk_add_f32 v[92:93], v[92:93], v[100:101]
    v_pk_add_f32 v[94:95], v[94:95], v[102:103]
    v_accvgpr_read_b32 v96, a72
    v_accvgpr_read_b32 v97, a73
    v_accvgpr_read_b32 v98, a74
    s_add_u32 m0, s15, 2048
    s_nop 0
    buffer_load_dwordx4 v154, s[16:19], s76 offen lds
    v_accvgpr_read_b32 v99, a75
    v_pk_add_f32 v[92:93], v[92:93], v[96:97]
    v_pk_add_f32 v[94:95], v[94:95], v[98:99]
    v_accvgpr_read_b32 v100, a76
    v_accvgpr_read_b32 v101, a77
    v_accvgpr_read_b32 v102, a78
    v_accvgpr_read_b32 v103, a79
    v_pk_add_f32 v[92:93], v[92:93], v[100:101]
    v_pk_add_f32 v[94:95], v[94:95], v[102:103]
    v_accvgpr_read_b32 v96, a80
    v_accvgpr_read_b32 v97, a81
    v_accvgpr_read_b32 v98, a82
    v_accvgpr_read_b32 v99, a83
    v_pk_add_f32 v[92:93], v[92:93], v[96:97]
    v_pk_add_f32 v[94:95], v[94:95], v[98:99]
    v_accvgpr_read_b32 v100, a84
    v_accvgpr_read_b32 v101, a85
    v_accvgpr_read_b32 v102, a86
    v_accvgpr_read_b32 v103, a87
    v_pk_add_f32 v[92:93], v[92:93], v[100:101]
    v_pk_add_f32 v[94:95], v[94:95], v[102:103]
    v_accvgpr_read_b32 v96, a88
    v_accvgpr_read_b32 v97, a89
    v_accvgpr_read_b32 v98, a90
    v_accvgpr_read_b32 v99, a91
    v_pk_add_f32 v[92:93], v[92:93], v[96:97]
    v_pk_add_f32 v[94:95], v[94:95], v[98:99]
    s_add_u32 m0, s15, 3072
    s_nop 0
    buffer_load_dwordx4 v155, s[16:19], s76 offen lds
    v_accvgpr_read_b32 v100, a92
    v_accvgpr_read_b32 v101, a93
    v_accvgpr_read_b32 v102, a94
    v_accvgpr_read_b32 v103, a95
    v_pk_add_f32 v[92:93], v[92:93], v[100:101]
    v_pk_add_f32 v[94:95], v[94:95], v[102:103]
    v_accvgpr_read_b32 v96, a96
    v_accvgpr_read_b32 v97, a97
    v_accvgpr_read_b32 v98, a98
    v_accvgpr_read_b32 v99, a99
    v_pk_add_f32 v[92:93], v[92:93], v[96:97]
    v_pk_add_f32 v[94:95], v[94:95], v[98:99]
    v_accvgpr_read_b32 v100, a100
    v_accvgpr_read_b32 v101, a101
    v_accvgpr_read_b32 v102, a102
    v_accvgpr_read_b32 v103, a103
    v_pk_add_f32 v[92:93], v[92:93], v[100:101]
    v_pk_add_f32 v[94:95], v[94:95], v[102:103]
    v_accvgpr_read_b32 v96, a104
    v_accvgpr_read_b32 v97, a105
    v_accvgpr_read_b32 v98, a106
    v_accvgpr_read_b32 v99, a107
    v_pk_add_f32 v[92:93], v[92:93], v[96:97]
    v_pk_add_f32 v[94:95], v[94:95], v[98:99]
    v_accvgpr_read_b32 v100, a108
    v_accvgpr_read_b32 v101, a109
    v_accvgpr_read_b32 v102, a110
    s_add_u32 m0, s15, 4096
    s_nop 0
    buffer_load_dwordx4 v156, s[16:19], s76 offen lds
    v_accvgpr_read_b32 v103, a111
    v_pk_add_f32 v[92:93], v[92:93], v[100:101]
    v_pk_add_f32 v[94:95], v[94:95], v[102:103]
    v_accvgpr_read_b32 v96, a112
    v_accvgpr_read_b32 v97, a113
    v_accvgpr_read_b32 v98, a114
    v_accvgpr_read_b32 v99, a115
    v_pk_add_f32 v[92:93], v[92:93], v[96:97]
    v_pk_add_f32 v[94:95], v[94:95], v[98:99]
    v_accvgpr_read_b32 v100, a116
    v_accvgpr_read_b32 v101, a117
    v_accvgpr_read_b32 v102, a118
    v_accvgpr_read_b32 v103, a119
    v_pk_add_f32 v[92:93], v[92:93], v[100:101]
    v_pk_add_f32 v[94:95], v[94:95], v[102:103]
    v_accvgpr_read_b32 v96, a120
    v_accvgpr_read_b32 v97, a121
    v_accvgpr_read_b32 v98, a122
    v_accvgpr_read_b32 v99, a123
    v_pk_add_f32 v[92:93], v[92:93], v[96:97]
    v_pk_add_f32 v[94:95], v[94:95], v[98:99]
    v_accvgpr_read_b32 v100, a124
    v_accvgpr_read_b32 v101, a125
    v_accvgpr_read_b32 v102, a126
    v_accvgpr_read_b32 v103, a127
    v_pk_add_f32 v[92:93], v[92:93], v[100:101]
    v_pk_add_f32 v[94:95], v[94:95], v[102:103]
    v_cvt_pk_bf16_f32 v16, v16, v17
    v_cvt_pk_bf16_f32 v17, v18, v19
    v_cvt_pk_bf16_f32 v92, v92, v93
    v_cvt_pk_bf16_f32 v93, v94, v95
    ds_write_b64 v56, v[16:17]
    ds_write_b64 v57, v[16:17]
    s_mov_b64 exec, s[70:71]
    ds_write_b64 v58, v[92:93]
    ds_write_b64 v59, v[92:93]
    s_mov_b64 exec, -1
    s_waitcnt lgkmcnt(0)
    s_barrier
    v_lshlrev_b32 v9, 4, v1
    v_add_u32 v9, 151232, v9
    ds_read_b128 v[92:95], v9 offset:0
    ds_read_b128 v[96:99], v9 offset:1024
    ds_read_b128 v[100:103], v9 offset:2048
    ds_read_b128 v[104:107], v9 offset:3072
    ds_read_b128 v[108:111], v9 offset:4096
    ds_read_b128 v[112:115], v9 offset:5120
    s_waitcnt lgkmcnt(3)
    v_mfma_f32_32x32x16_bf16 v[16:31], v[92:95], v[220:223], 0
    v_mfma_f32_32x32x16_bf16 v[16:31], v[96:99], v[224:227], v[16:31]
    v_mfma_f32_32x32x16_bf16 v[16:31], v[100:103], v[228:231], v[16:31]
    s_waitcnt lgkmcnt(0)
    v_mfma_f32_32x32x16_bf16 v[32:47], v[104:107], v[232:235], 0
    v_mfma_f32_32x32x16_bf16 v[32:47], v[108:111], v[236:239], v[32:47]
    v_mfma_f32_32x32x16_bf16 v[32:47], v[112:115], v[240:243], v[32:47]
    v_accvgpr_read_b32 v10, a217
    v_accvgpr_read_b32 v11, a218
    v_mov_b32 v12, 0x358637bd
    s_nop 4
    v_add_f32 v26, v26, v12
    v_rcp_f32 v26, v26
    s_nop 1
    v_add_f32 v42, v42, v12
    v_rcp_f32 v42, v42
    v_pk_mul_f32 v[16:17], v[16:17], v[26:27] op_sel_hi:[1,0]
    v_pk_mul_f32 v[18:19], v[18:19], v[26:27] op_sel_hi:[1,0]
    v_pk_mul_f32 v[20:21], v[20:21], v[26:27] op_sel_hi:[1,0]
    v_pk_mul_f32 v[22:23], v[22:23], v[26:27] op_sel_hi:[1,0]
    v_pk_mul_f32 v[24:25], v[24:25], v[26:27] op_sel_hi:[1,0]
    v_cvt_pk_bf16_f32 v160, v16, v17
    v_cvt_pk_bf16_f32 v161, v18, v19
    v_cvt_pk_bf16_f32 v162, v20, v21
    v_cvt_pk_bf16_f32 v163, v22, v23
    v_cvt_pk_bf16_f32 v164, v24, v25
    v_pk_mul_f32 v[32:33], v[32:33], v[42:43] op_sel_hi:[1,0]
    v_pk_mul_f32 v[34:35], v[34:35], v[42:43] op_sel_hi:[1,0]
    v_pk_mul_f32 v[36:37], v[36:37], v[42:43] op_sel_hi:[1,0]
    v_pk_mul_f32 v[38:39], v[38:39], v[42:43] op_sel_hi:[1,0]
    v_pk_mul_f32 v[40:41], v[40:41], v[42:43] op_sel_hi:[1,0]
    v_cvt_pk_bf16_f32 v166, v32, v33
    v_cvt_pk_bf16_f32 v167, v34, v35
    v_cvt_pk_bf16_f32 v168, v36, v37
    v_cvt_pk_bf16_f32 v169, v38, v39
    v_cvt_pk_bf16_f32 v170, v40, v41
    v_mov_b32 v172, v164
    v_mov_b32 v173, v170
    s_nop 1
    v_permlane32_swap_b32 v172, v173
    buffer_store_dwordx4 v[160:163], v10, s[44:47], s84 offen sc1
    buffer_store_dwordx2 v[172:173], v11, s[44:47], s84 offen offset:2048 sc1
    buffer_store_dwordx4 v[166:169], v10, s[44:47], s84 offen offset:3072 sc1
    s_cmp_lt_u32 s22, 108
    s_cbranch_scc1 L_moea
    s_nop 0
    v_cmp_gt_f32 vcc, v50, v48
    s_nop 1
    v_cndmask_b32 v48, v48, v50, vcc
    v_cndmask_b32 v49, v49, v51, vcc
    v_cmp_gt_f32 vcc, v52, v48
    s_nop 1
    v_cndmask_b32 v48, v48, v52, vcc
    v_cndmask_b32 v49, v49, v53, vcc
    v_cmp_gt_f32 vcc, v54, v48
    s_nop 1
    v_cndmask_b32 v48, v48, v54, vcc
    v_cndmask_b32 v49, v49, v55, vcc
    v_mov_b32 v50, v48
    s_nop 1
    v_max_f32_dpp v50, v50, v50 row_shr:1 row_mask:0xf bank_mask:0xf
    s_nop 1
    v_max_f32_dpp v50, v50, v50 row_shr:2 row_mask:0xf bank_mask:0xf
    s_nop 1
    v_max_f32_dpp v50, v50, v50 row_shr:4 row_mask:0xf bank_mask:0xf
    s_nop 1
    v_max_f32_dpp v50, v50, v50 row_shr:8 row_mask:0xf bank_mask:0xf
    s_nop 1
    v_max_f32_dpp v50, v50, v50 row_bcast:15 row_mask:0xa bank_mask:0xf
    s_nop 1
    v_max_f32_dpp v50, v50, v50 row_bcast:31 row_mask:0xc bank_mask:0xf
    s_nop 0
    v_readlane_b32 s23, v50, 63
    s_nop 1
    v_cmp_eq_f32 vcc, s23, v48
    s_nop 0
    s_ff1_i32_b64 s62, vcc
    s_max_i32 s62, s62, 0
    v_readlane_b32 s83, v49, s62
    s_nop 0
    s_and_b32 s83, s83, 2047
    s_branch L_moeadone
L_moea:
    s_waitcnt vmcnt(10)
    v_rcp_f32 v67, v67
    v_lshlrev_b32 v168, 16, v60
    v_and_b32 v169, 0xffff0000, v60
    v_sub_f32 v168, v168, v66
    v_sub_f32 v169, v169, v66
    v_cvt_pk_bf16_f32 v168, v168, v169
    v_lshlrev_b32 v169, 16, v168
    v_and_b32 v168, 0xffff0000, v168
    v_mul_f32 v169, v169, v67
    v_mul_f32 v168, v168, v67
    v_cvt_pk_bf16_f32 v60, v169, v168
    v_lshlrev_b32 v168, 16, v61
    v_and_b32 v169, 0xffff0000, v61
    v_sub_f32 v168, v168, v66
    v_sub_f32 v169, v169, v66
    v_cvt_pk_bf16_f32 v168, v168, v169
    v_lshlrev_b32 v169, 16, v168
    v_and_b32 v168, 0xffff0000, v168
    v_mul_f32 v169, v169, v67
    v_mul_f32 v168, v168, v67
    v_cvt_pk_bf16_f32 v61, v169, v168
    v_lshlrev_b32 v168, 16, v62
    v_and_b32 v169, 0xffff0000, v62
    v_sub_f32 v168, v168, v66
    v_sub_f32 v169, v169, v66
    v_cvt_pk_bf16_f32 v168, v168, v169
    v_lshlrev_b32 v169, 16, v168
    v_and_b32 v168, 0xffff0000, v168
    v_mul_f32 v169, v169, v67
    v_mul_f32 v168, v168, v67
    v_cvt_pk_bf16_f32 v62, v169, v168
    v_lshlrev_b32 v168, 16, v63
    v_and_b32 v169, 0xffff0000, v63
    v_sub_f32 v168, v168, v66
    v_sub_f32 v169, v169, v66
    v_cvt_pk_bf16_f32 v168, v168, v169
    v_lshlrev_b32 v169, 16, v168
    v_and_b32 v168, 0xffff0000, v168
    v_mul_f32 v169, v169, v67
    v_mul_f32 v168, v168, v67
    v_cvt_pk_bf16_f32 v63, v169, v168
    v_lshlrev_b32 v168, 16, v64
    v_and_b32 v169, 0xffff0000, v64
    v_sub_f32 v168, v168, v66
    v_sub_f32 v169, v169, v66
    v_cvt_pk_bf16_f32 v168, v168, v169
    v_lshlrev_b32 v169, 16, v168
    v_and_b32 v168, 0xffff0000, v168
    v_mul_f32 v169, v169, v67
    v_mul_f32 v168, v168, v67
    v_cvt_pk_bf16_f32 v64, v169, v168
    s_mul_i32 s62, s3, 1280
    s_add_u32 s62, s62, 157376
    v_mul_u32_u24 v9, 20, v1
    v_add_u32 v9, s62, v9
    ds_write_b32 v9, v60
    ds_write_b32 v9, v61 offset:4
    ds_write_b32 v9, v62 offset:8
    ds_write_b32 v9, v63 offset:12
    ds_write_b32 v9, v64 offset:16
    v_bfe_u32 v9, v1, 2, 2
    v_lshl_add_u32 v9, v3, 3, v9
    s_mul_i32 s63, s3, 160
    v_add_u32 v9, s63, v9
    v_lshlrev_b32 v9, 5, v9
    v_and_b32 v10, 3, v1
    v_lshl_add_u32 v9, v10, 3, v9
    v_bfe_u32 v10, v1, 4, 1
    v_mul_u32_u24 v10, 20608, v10
    v_add_u32 v9, v9, v10
    v_add_u32 v9, 102400, v9
    s_mul_i32 s63, s3, 320
    s_add_u32 s62, s62, s63
    v_lshlrev_b32 v10, 4, v3
    v_add_u32 v10, s62, v10
    s_waitcnt lgkmcnt(0)
    ds_read_b64_tr_b16 v[32:33], v9 offset:0
    ds_read_b64_tr_b16 v[34:35], v9 offset:128
    ds_read_b128 v[36:39], v10 offset:0
    ds_read_b64_tr_b16 v[40:41], v9 offset:512
    ds_read_b64_tr_b16 v[42:43], v9 offset:640
    ds_read_b128 v[44:47], v10 offset:32
    ds_read_b64_tr_b16 v[48:49], v9 offset:1024
    ds_read_b64_tr_b16 v[50:51], v9 offset:1152
    ds_read_b128 v[52:55], v10 offset:64
    ds_read_b64_tr_b16 v[56:57], v9 offset:1536
    ds_read_b64_tr_b16 v[58:59], v9 offset:1664
    ds_read_b128 v[60:63], v10 offset:96
    s_waitcnt lgkmcnt(9)
    v_mfma_f32_32x32x16_bf16 v[16:31], v[32:35], v[36:39], 0
    ds_read_b64_tr_b16 v[64:65], v9 offset:2048
    ds_read_b64_tr_b16 v[66:67], v9 offset:2176
    ds_read_b128 v[68:71], v10 offset:128
    s_waitcnt lgkmcnt(9)
    v_mfma_f32_32x32x16_bf16 v[16:31], v[40:43], v[44:47], v[16:31]
    ds_read_b64_tr_b16 v[72:73], v9 offset:2560
    ds_read_b64_tr_b16 v[74:75], v9 offset:2688
    ds_read_b128 v[76:79], v10 offset:160
    s_waitcnt lgkmcnt(9)
    v_mfma_f32_32x32x16_bf16 v[16:31], v[48:51], v[52:55], v[16:31]
    ds_read_b64_tr_b16 v[80:81], v9 offset:3072
    ds_read_b64_tr_b16 v[82:83], v9 offset:3200
    ds_read_b128 v[84:87], v10 offset:192
    s_waitcnt lgkmcnt(9)
    v_mfma_f32_32x32x16_bf16 v[16:31], v[56:59], v[60:63], v[16:31]
    ds_read_b64_tr_b16 v[88:89], v9 offset:3584
    ds_read_b64_tr_b16 v[90:91], v9 offset:3712
    ds_read_b128 v[92:95], v10 offset:224
    s_waitcnt lgkmcnt(9)
    v_mfma_f32_32x32x16_bf16 v[16:31], v[64:67], v[68:71], v[16:31]
    ds_read_b64_tr_b16 v[96:97], v9 offset:4096
    ds_read_b64_tr_b16 v[98:99], v9 offset:4224
    ds_read_b128 v[100:103], v10 offset:256
    s_waitcnt lgkmcnt(9)
    v_mfma_f32_32x32x16_bf16 v[16:31], v[72:75], v[76:79], v[16:31]
    ds_read_b64_tr_b16 v[104:105], v9 offset:4608
    ds_read_b64_tr_b16 v[106:107], v9 offset:4736
    ds_read_b128 v[108:111], v10 offset:288
    s_waitcnt lgkmcnt(9)
    v_mfma_f32_32x32x16_bf16 v[16:31], v[80:83], v[84:87], v[16:31]
    s_waitcnt lgkmcnt(6)
    v_mfma_f32_32x32x16_bf16 v[16:31], v[88:91], v[92:95], v[16:31]
    s_waitcnt lgkmcnt(3)
    v_mfma_f32_32x32x16_bf16 v[16:31], v[96:99], v[100:103], v[16:31]
    s_waitcnt lgkmcnt(0)
    v_mfma_f32_32x32x16_bf16 v[16:31], v[104:107], v[108:111], v[16:31]
    s_lshl_b32 s62, s3, 7
    s_add_u32 s62, s62, 162496
    v_lshlrev_b32 v9, 4, v3
    v_add_u32 v9, s62, v9
    s_mov_b32 exec_lo, 1
    s_mov_b32 exec_hi, 1
    s_nop 5
    ds_write_b128 v9, v[16:19]
    ds_write_b128 v9, v[20:23] offset:32
    ds_write_b128 v9, v[24:27] offset:64
    ds_write_b128 v9, v[28:31] offset:96
    s_mov_b64 exec, -1
    s_waitcnt lgkmcnt(0)
    s_nop 0
L_moeadone:
    s_waitcnt vmcnt(0)
    s_barrier
    s_cmp_lg_u32 s3, 0
    s_cbranch_scc1 L_nosig_o
    s_add_u32 s62, s50, 16
    s_lshl_b32 s62, s62, 7
    v_mov_b32 v9, s62
    v_mov_b32 v10, 1
    s_mov_b64 exec, 1
    buffer_atomic_add v10, v9, s[44:47], 0 offen sc1
    s_mov_b64 exec, -1
L_nosig_o:
    s_cmp_ge_u32 s22, 108
    s_cbranch_scc1 L_wodone
    s_nop 0
    v_and_b32 v9, 15, v1
    v_lshlrev_b32 v9, 2, v9
    v_add_u32 v9, 162496, v9
    ds_read_b32 v160, v9
    ds_read_b32 v161, v9 offset:128
    ds_read_b32 v162, v9 offset:256
    ds_read_b32 v163, v9 offset:384
    ds_read_b32 v164, v9 offset:64
    ds_read_b32 v165, v9 offset:192
    ds_read_b32 v166, v9 offset:320
    ds_read_b32 v167, v9 offset:448
    s_waitcnt lgkmcnt(0)
    v_add_f32 v160, v160, v161
    v_add_f32 v162, v162, v163
    v_add_f32 v164, v164, v165
    v_add_f32 v166, v166, v167
    v_add_f32 v160, v160, v162
    v_add_f32 v164, v164, v166
    v_cvt_pk_bf16_f32 v160, v160, v160
    v_lshlrev_b32 v160, 16, v160
    v_cvt_pk_bf16_f32 v164, v164, v164
    v_lshlrev_b32 v164, 16, v164
    v_mul_f32 v161, 0xbfb8aa3b, v160
    v_exp_f32 v161, v161
    s_nop 0
    v_add_f32 v161, 1.0, v161
    v_rcp_f32 v161, v161
    s_nop 0
    v_mul_f32 v160, v160, v161
    v_cvt_pk_bf16_f32 v160, v160, v160
    v_lshlrev_b32 v160, 16, v160
    v_mul_f32 v160, v160, v164
    v_cvt_pk_bf16_f32 v160, v160, v160
    v_lshlrev_b32 v160, 16, v160
    v_mov_b32 v161, v160
    s_nop 1
    v_mov_b32_dpp v161, v160 row_shl:1 row_mask:0xf bank_mask:0xf
    s_nop 1
    v_cvt_pk_bf16_f32 v160, v160, v161
    v_mov_b32 v16, 0
    v_mov_b32 v17, 0
    v_mov_b32 v18, 0
    v_mov_b32 v19, 0
    s_mov_b32 s74, 0x05040100
    v_mov_b32 v26, s74
    s_mov_b32 s74, 0x07060302
    v_mov_b32 v27, s74
    v_readlane_b32 s74, v160, 0
    v_accvgpr_read_b32 v20, a160
    v_accvgpr_read_b32 v21, a161
    v_accvgpr_read_b32 v22, a162
    v_accvgpr_read_b32 v23, a163
    v_perm_b32 v24, v22, v20, v26
    v_perm_b32 v25, v22, v20, v27
    v_perm_b32 v28, v23, v21, v26
    v_perm_b32 v29, v23, v21, v27
    v_dot2c_f32_bf16 v16, s74, v24
    v_dot2c_f32_bf16 v17, s74, v25
    v_dot2c_f32_bf16 v18, s74, v28
    v_dot2c_f32_bf16 v19, s74, v29
    v_readlane_b32 s74, v160, 2
    v_accvgpr_read_b32 v20, a164
    v_accvgpr_read_b32 v21, a165
    v_accvgpr_read_b32 v22, a166
    v_accvgpr_read_b32 v23, a167
    v_perm_b32 v24, v22, v20, v26
    v_perm_b32 v25, v22, v20, v27
    v_perm_b32 v28, v23, v21, v26
    v_perm_b32 v29, v23, v21, v27
    v_dot2c_f32_bf16 v16, s74, v24
    v_dot2c_f32_bf16 v17, s74, v25
    v_dot2c_f32_bf16 v18, s74, v28
    v_dot2c_f32_bf16 v19, s74, v29
    v_readlane_b32 s74, v160, 4
    v_accvgpr_read_b32 v20, a168
    v_accvgpr_read_b32 v21, a169
    v_accvgpr_read_b32 v22, a170
    v_accvgpr_read_b32 v23, a171
    v_perm_b32 v24, v22, v20, v26
    v_perm_b32 v25, v22, v20, v27
    v_perm_b32 v28, v23, v21, v26
    v_perm_b32 v29, v23, v21, v27
    v_dot2c_f32_bf16 v16, s74, v24
    v_dot2c_f32_bf16 v17, s74, v25
    v_dot2c_f32_bf16 v18, s74, v28
    v_dot2c_f32_bf16 v19, s74, v29
    v_readlane_b32 s74, v160, 6
    v_accvgpr_read_b32 v20, a172
    v_accvgpr_read_b32 v21, a173
    v_accvgpr_read_b32 v22, a174
    v_accvgpr_read_b32 v23, a175
    v_perm_b32 v24, v22, v20, v26
    v_perm_b32 v25, v22, v20, v27
    v_perm_b32 v28, v23, v21, v26
    v_perm_b32 v29, v23, v21, v27
    v_dot2c_f32_bf16 v16, s74, v24
    v_dot2c_f32_bf16 v17, s74, v25
    v_dot2c_f32_bf16 v18, s74, v28
    v_dot2c_f32_bf16 v19, s74, v29
    v_readlane_b32 s74, v160, 8
    v_accvgpr_read_b32 v20, a176
    v_accvgpr_read_b32 v21, a177
    v_accvgpr_read_b32 v22, a178
    v_accvgpr_read_b32 v23, a179
    v_perm_b32 v24, v22, v20, v26
    v_perm_b32 v25, v22, v20, v27
    v_perm_b32 v28, v23, v21, v26
    v_perm_b32 v29, v23, v21, v27
    v_dot2c_f32_bf16 v16, s74, v24
    v_dot2c_f32_bf16 v17, s74, v25
    v_dot2c_f32_bf16 v18, s74, v28
    v_dot2c_f32_bf16 v19, s74, v29
    v_readlane_b32 s74, v160, 10
    v_accvgpr_read_b32 v20, a180
    v_accvgpr_read_b32 v21, a181
    v_accvgpr_read_b32 v22, a182
    v_accvgpr_read_b32 v23, a183
    v_perm_b32 v24, v22, v20, v26
    v_perm_b32 v25, v22, v20, v27
    v_perm_b32 v28, v23, v21, v26
    v_perm_b32 v29, v23, v21, v27
    v_dot2c_f32_bf16 v16, s74, v24
    v_dot2c_f32_bf16 v17, s74, v25
    v_dot2c_f32_bf16 v18, s74, v28
    v_dot2c_f32_bf16 v19, s74, v29
    v_readlane_b32 s74, v160, 12
    v_accvgpr_read_b32 v20, a184
    v_accvgpr_read_b32 v21, a185
    v_accvgpr_read_b32 v22, a186
    v_accvgpr_read_b32 v23, a187
    v_perm_b32 v24, v22, v20, v26
    v_perm_b32 v25, v22, v20, v27
    v_perm_b32 v28, v23, v21, v26
    v_perm_b32 v29, v23, v21, v27
    v_dot2c_f32_bf16 v16, s74, v24
    v_dot2c_f32_bf16 v17, s74, v25
    v_dot2c_f32_bf16 v18, s74, v28
    v_dot2c_f32_bf16 v19, s74, v29
    v_readlane_b32 s74, v160, 14
    v_accvgpr_read_b32 v20, a188
    v_accvgpr_read_b32 v21, a189
    v_accvgpr_read_b32 v22, a190
    v_accvgpr_read_b32 v23, a191
    v_perm_b32 v24, v22, v20, v26
    v_perm_b32 v25, v22, v20, v27
    v_perm_b32 v28, v23, v21, v26
    v_perm_b32 v29, v23, v21, v27
    v_dot2c_f32_bf16 v16, s74, v24
    v_dot2c_f32_bf16 v17, s74, v25
    v_dot2c_f32_bf16 v18, s74, v28
    v_dot2c_f32_bf16 v19, s74, v29
    s_nop 2
    s_movk_i32 s63, 0xff
    s_lshr_b32 s64, s82, 8
    s_lshr_b32 s65, s82, 16
    s_lshr_b32 s66, s82, 24
    v_mov_b32 v20, s82
    v_mov_b32 v21, s64
    v_mov_b32 v22, s65
    v_mov_b32 v23, s66
    v_bfi_b32 v16, s63, v20, v16
    v_bfi_b32 v17, s63, v21, v17
    v_bfi_b32 v18, s63, v22, v18
    v_bfi_b32 v19, s63, v23, v19
    s_mul_i32 s62, s22, 2560
    s_add_u32 s62, s62, 5308416
    v_lshlrev_b32 v9, 4, v0
    v_cmp_gt_u32 vcc, 160, v0
    s_nop 0
    s_and_saveexec_b64 s[68:69], vcc
    s_cbranch_execz L_noy
    buffer_store_dwordx4 v[16:19], v9, s[44:47], s62 offen sc1
L_noy:
    s_mov_b64 exec, -1
    s_nop 0
L_wodone:
    v_bfe_u32 v10, v1, 5, 1
    v_lshlrev_b32 v10, 3, v10
    v_bfe_u32 v11, v1, 4, 1
    v_lshl_add_u32 v10, v11, 2, v10
    v_bfe_u32 v11, v1, 2, 2
    v_add_u32 v10, v10, v11
    v_mul_u32_u24 v10, 160, v10
    v_and_b32 v11, 3, v1
    v_lshl_add_u32 v10, v11, 3, v10
    v_add_u32 v236, 0, v10
    v_add_u32 v237, 51200, v10
    s_lshr_b32 s62, s20, 1
    s_add_u32 s62, s62, 16
    s_lshl_b32 s62, s62, 7
    v_mov_b32 v238, s62
    s_mov_b32 exec_lo, 1
    s_mov_b32 exec_hi, 0
    buffer_load_dword v239, v238, s[44:47], 0 offen sc1
    s_mov_b64 exec, -1
    ds_read_b64_tr_b16 a[0:1], v236 offset:0
    ds_read_b64_tr_b16 a[2:3], v236 offset:2560
    ds_read_b64_tr_b16 a[4:5], v236 offset:32
    ds_read_b64_tr_b16 a[6:7], v236 offset:2592
    ds_read_b64_tr_b16 a[8:9], v236 offset:64
    ds_read_b64_tr_b16 a[10:11], v236 offset:2624
    ds_read_b64_tr_b16 a[12:13], v236 offset:96
    ds_read_b64_tr_b16 a[14:15], v236 offset:2656
    ds_read_b64_tr_b16 a[16:17], v236 offset:128
    ds_read_b64_tr_b16 a[18:19], v236 offset:2688
    s_waitcnt lgkmcnt(5)
    ds_read_b64_tr_b16 a[20:21], v236 offset:5120
    ds_read_b64_tr_b16 a[22:23], v236 offset:7680
    ds_read_b64_tr_b16 a[24:25], v236 offset:5152
    ds_read_b64_tr_b16 a[26:27], v236 offset:7712
    ds_read_b64_tr_b16 a[28:29], v236 offset:5184
    ds_read_b64_tr_b16 a[30:31], v236 offset:7744
    ds_read_b64_tr_b16 a[32:33], v236 offset:5216
    ds_read_b64_tr_b16 a[34:35], v236 offset:7776
    ds_read_b64_tr_b16 a[36:37], v236 offset:5248
    ds_read_b64_tr_b16 a[38:39], v236 offset:7808
    s_waitcnt lgkmcnt(5)
    ds_read_b64_tr_b16 a[40:41], v236 offset:10240
    ds_read_b64_tr_b16 a[42:43], v236 offset:12800
    ds_read_b64_tr_b16 a[44:45], v236 offset:10272
    ds_read_b64_tr_b16 a[46:47], v236 offset:12832
    ds_read_b64_tr_b16 a[48:49], v236 offset:10304
    ds_read_b64_tr_b16 a[50:51], v236 offset:12864
    ds_read_b64_tr_b16 a[52:53], v236 offset:10336
    ds_read_b64_tr_b16 a[54:55], v236 offset:12896
    ds_read_b64_tr_b16 a[56:57], v236 offset:10368
    ds_read_b64_tr_b16 a[58:59], v236 offset:12928
    s_waitcnt lgkmcnt(5)
    ds_read_b64_tr_b16 a[60:61], v236 offset:15360
    ds_read_b64_tr_b16 a[62:63], v236 offset:17920
    ds_read_b64_tr_b16 a[64:65], v236 offset:15392
    ds_read_b64_tr_b16 a[66:67], v236 offset:17952
    ds_read_b64_tr_b16 a[68:69], v236 offset:15424
    ds_read_b64_tr_b16 a[70:71], v236 offset:17984
    ds_read_b64_tr_b16 a[72:73], v236 offset:15456
    ds_read_b64_tr_b16 a[74:75], v236 offset:18016
    ds_read_b64_tr_b16 a[76:77], v236 offset:15488
    ds_read_b64_tr_b16 a[78:79], v236 offset:18048
    s_waitcnt lgkmcnt(5)
    ds_read_b64_tr_b16 a[80:81], v236 offset:20480
    ds_read_b64_tr_b16 a[82:83], v236 offset:23040
    ds_read_b64_tr_b16 a[84:85], v236 offset:20512
    ds_read_b64_tr_b16 a[86:87], v236 offset:23072
    ds_read_b64_tr_b16 a[88:89], v236 offset:20544
    ds_read_b64_tr_b16 a[90:91], v236 offset:23104
    ds_read_b64_tr_b16 a[92:93], v236 offset:20576
    ds_read_b64_tr_b16 a[94:95], v236 offset:23136
    ds_read_b64_tr_b16 a[96:97], v236 offset:20608
    ds_read_b64_tr_b16 a[98:99], v236 offset:23168
    s_waitcnt lgkmcnt(5)
    ds_read_b64_tr_b16 a[100:101], v236 offset:25600
    ds_read_b64_tr_b16 a[102:103], v236 offset:28160
    ds_read_b64_tr_b16 a[104:105], v236 offset:25632
    ds_read_b64_tr_b16 a[106:107], v236 offset:28192
    ds_read_b64_tr_b16 a[108:109], v236 offset:25664
    ds_read_b64_tr_b16 a[110:111], v236 offset:28224
    ds_read_b64_tr_b16 a[112:113], v236 offset:25696
    ds_read_b64_tr_b16 a[114:115], v236 offset:28256
    ds_read_b64_tr_b16 a[116:117], v236 offset:25728
    ds_read_b64_tr_b16 a[118:119], v236 offset:28288
    s_waitcnt lgkmcnt(5)
    ds_read_b64_tr_b16 a[120:121], v236 offset:30720
    ds_read_b64_tr_b16 a[122:123], v236 offset:33280
    ds_read_b64_tr_b16 a[124:125], v236 offset:30752
    ds_read_b64_tr_b16 a[126:127], v236 offset:33312
    ds_read_b64_tr_b16 a[128:129], v236 offset:30784
    ds_read_b64_tr_b16 a[130:131], v236 offset:33344
    ds_read_b64_tr_b16 a[132:133], v236 offset:30816
    ds_read_b64_tr_b16 a[134:135], v236 offset:33376
    ds_read_b64_tr_b16 a[136:137], v236 offset:30848
    ds_read_b64_tr_b16 a[138:139], v236 offset:33408
    s_waitcnt lgkmcnt(5)
    ds_read_b64_tr_b16 a[140:141], v236 offset:35840
    ds_read_b64_tr_b16 a[142:143], v236 offset:38400
    ds_read_b64_tr_b16 a[144:145], v236 offset:35872
    ds_read_b64_tr_b16 a[146:147], v236 offset:38432
    ds_read_b64_tr_b16 a[148:149], v236 offset:35904
    ds_read_b64_tr_b16 a[150:151], v236 offset:38464
    ds_read_b64_tr_b16 a[152:153], v236 offset:35936
    ds_read_b64_tr_b16 a[154:155], v236 offset:38496
    ds_read_b64_tr_b16 a[156:157], v236 offset:35968
    ds_read_b64_tr_b16 a[158:159], v236 offset:38528
    s_waitcnt lgkmcnt(5)
    ds_read_b64_tr_b16 a[160:161], v236 offset:40960
    ds_read_b64_tr_b16 a[162:163], v236 offset:43520
    ds_read_b64_tr_b16 a[164:165], v236 offset:40992
    ds_read_b64_tr_b16 a[166:167], v236 offset:43552
    ds_read_b64_tr_b16 a[168:169], v236 offset:41024
    ds_read_b64_tr_b16 a[170:171], v236 offset:43584
    ds_read_b64_tr_b16 a[172:173], v236 offset:41056
    ds_read_b64_tr_b16 a[174:175], v236 offset:43616
    ds_read_b64_tr_b16 a[176:177], v236 offset:41088
    ds_read_b64_tr_b16 a[178:179], v236 offset:43648
    s_waitcnt lgkmcnt(5)
    ds_read_b64_tr_b16 a[180:181], v236 offset:46080
    ds_read_b64_tr_b16 a[182:183], v236 offset:48640
    ds_read_b64_tr_b16 a[184:185], v236 offset:46112
    ds_read_b64_tr_b16 a[186:187], v236 offset:48672
    ds_read_b64_tr_b16 a[188:189], v236 offset:46144
    ds_read_b64_tr_b16 a[190:191], v236 offset:48704
    ds_read_b64_tr_b16 a[192:193], v236 offset:46176
    ds_read_b64_tr_b16 a[194:195], v236 offset:48736
    ds_read_b64_tr_b16 a[196:197], v236 offset:46208
    ds_read_b64_tr_b16 a[198:199], v236 offset:48768
    s_waitcnt lgkmcnt(5)
    ds_read_b64_tr_b16 a[200:201], v237 offset:0
    ds_read_b64_tr_b16 a[202:203], v237 offset:2560
    ds_read_b64_tr_b16 a[204:205], v237 offset:32
    ds_read_b64_tr_b16 a[206:207], v237 offset:2592
    ds_read_b64_tr_b16 a[208:209], v237 offset:64
    ds_read_b64_tr_b16 a[210:211], v237 offset:2624
    ds_read_b64_tr_b16 a[212:213], v237 offset:96
    ds_read_b64_tr_b16 a[214:215], v237 offset:2656
    ds_read_b64_tr_b16 a[216:217], v237 offset:128
    ds_read_b64_tr_b16 a[218:219], v237 offset:2688
    s_waitcnt lgkmcnt(5)
    ds_read_b64_tr_b16 a[220:221], v237 offset:5120
    ds_read_b64_tr_b16 a[222:223], v237 offset:7680
    ds_read_b64_tr_b16 a[224:225], v237 offset:5152
    ds_read_b64_tr_b16 a[226:227], v237 offset:7712
    ds_read_b64_tr_b16 a[228:229], v237 offset:5184
    ds_read_b64_tr_b16 a[230:231], v237 offset:7744
    ds_read_b64_tr_b16 a[232:233], v237 offset:5216
    ds_read_b64_tr_b16 a[234:235], v237 offset:7776
    ds_read_b64_tr_b16 a[236:237], v237 offset:5248
    ds_read_b64_tr_b16 a[238:239], v237 offset:7808
    s_waitcnt lgkmcnt(5)
    ds_read_b64_tr_b16 v[40:41], v237 offset:10240
    ds_read_b64_tr_b16 v[42:43], v237 offset:12800
    ds_read_b64_tr_b16 v[44:45], v237 offset:10272
    ds_read_b64_tr_b16 v[46:47], v237 offset:12832
    ds_read_b64_tr_b16 v[48:49], v237 offset:10304
    ds_read_b64_tr_b16 v[50:51], v237 offset:12864
    ds_read_b64_tr_b16 v[52:53], v237 offset:10336
    ds_read_b64_tr_b16 v[54:55], v237 offset:12896
    ds_read_b64_tr_b16 v[56:57], v237 offset:10368
    ds_read_b64_tr_b16 v[58:59], v237 offset:12928
    s_waitcnt lgkmcnt(5)
    ds_read_b64_tr_b16 v[60:61], v237 offset:15360
    ds_read_b64_tr_b16 v[62:63], v237 offset:17920
    ds_read_b64_tr_b16 v[64:65], v237 offset:15392
    ds_read_b64_tr_b16 v[66:67], v237 offset:17952
    ds_read_b64_tr_b16 v[68:69], v237 offset:15424
    ds_read_b64_tr_b16 v[70:71], v237 offset:17984
    ds_read_b64_tr_b16 v[72:73], v237 offset:15456
    ds_read_b64_tr_b16 v[74:75], v237 offset:18016
    ds_read_b64_tr_b16 v[76:77], v237 offset:15488
    ds_read_b64_tr_b16 v[78:79], v237 offset:18048
    s_lshl_b32 s62, s20, 6
    s_sub_u32 s80, s83, s62
    s_cmp_ge_u32 s80, 64
    s_cbranch_scc1 L_noown0
    v_min_u32 v10, 19, v1
    v_lshlrev_b32 v10, 3, v10
    s_mul_i32 s62, s83, 1280
    s_mul_i32 s63, s21, 160
    s_add_u32 s62, s62, s63
    buffer_load_dwordx2 v[200:201], v10, s[4:7], s62 offen
    s_lshl_b32 s62, s83, 3
    s_add_u32 s62, s62, 5242880
    v_mov_b32 v10, 0
    buffer_load_dwordx2 v[202:203], v10, s[44:47], s62 offen sc1
L_noown0:
    s_mov_b32 exec_lo, 1
    s_mov_b32 exec_hi, 0
    s_mov_b32 s74, 0
    s_waitcnt vmcnt(0)
    v_cmp_gt_u32 vcc, 16, v239
    s_cbranch_vccz L_poll_o_out
L_poll_o:
    buffer_load_dword v239, v238, s[44:47], 0 offen sc1
    s_add_u32 s74, s74, 1
    s_cmp_gt_u32 s74, 200000
    s_cbranch_scc1 L_poll_o_out
    s_waitcnt vmcnt(0)
    v_cmp_gt_u32 vcc, 16, v239
    s_cbranch_vccnz L_poll_o
L_poll_o_out:
    s_waitcnt vmcnt(0)
    s_mov_b64 exec, -1
    s_mul_i32 s62, s20, 81920
    s_mul_i32 s63, s3, 20480
    s_add_u32 s62, s62, s63
    s_add_u32 s62, s62, 2097152
    v_lshlrev_b32 v9, 4, v1
    buffer_load_dwordx4 v[100:103], v9, s[44:47], s62 offen sc1
    s_add_u32 s62, s62, 1024
    buffer_load_dwordx4 v[104:107], v9, s[44:47], s62 offen sc1
    s_add_u32 s62, s62, 1024
    buffer_load_dwordx4 v[108:111], v9, s[44:47], s62 offen sc1
    s_add_u32 s62, s62, 1024
    buffer_load_dwordx4 v[112:115], v9, s[44:47], s62 offen sc1
    s_add_u32 s62, s62, 1024
    buffer_load_dwordx4 v[116:119], v9, s[44:47], s62 offen sc1
    s_add_u32 s62, s62, 1024
    buffer_load_dwordx4 v[120:123], v9, s[44:47], s62 offen sc1
    s_add_u32 s62, s62, 1024
    buffer_load_dwordx4 v[124:127], v9, s[44:47], s62 offen sc1
    s_add_u32 s62, s62, 1024
    buffer_load_dwordx4 v[146:149], v9, s[44:47], s62 offen sc1
    s_add_u32 s62, s62, 1024
    buffer_load_dwordx4 v[150:153], v9, s[44:47], s62 offen sc1
    s_add_u32 s62, s62, 1024
    buffer_load_dwordx4 v[154:157], v9, s[44:47], s62 offen sc1
    s_add_u32 s62, s62, 1024
    s_cmp_ge_u32 s80, 64
    s_cbranch_scc1 L_noownp
    v_mov_b32 v205, s23
    v_cvt_pk_bf16_f32 v205, v205, v205
    v_lshlrev_b32 v205, 16, v205
    v_mul_f32 v205, 0xbfb8aa3b, v205
    v_exp_f32 v205, v205
    v_rcp_f32 v203, v203
    v_add_f32 v205, 1.0, v205
    v_rcp_f32 v205, v205
    v_lshlrev_b32 v206, 16, v200
    v_and_b32 v207, 0xffff0000, v200
    v_lshlrev_b32 v208, 16, v201
    v_and_b32 v209, 0xffff0000, v201
    v_cvt_pk_bf16_f32 v205, v205, v205
    v_lshlrev_b32 v205, 16, v205
    v_sub_f32 v206, v206, v202
    v_cvt_pk_bf16_f32 v206, v206, v206
    v_lshlrev_b32 v206, 16, v206
    v_mul_f32 v206, v206, v203
    v_cvt_pk_bf16_f32 v206, v206, v206
    v_lshlrev_b32 v206, 16, v206
    v_sub_f32 v207, v207, v202
    v_cvt_pk_bf16_f32 v207, v207, v207
    v_lshlrev_b32 v207, 16, v207
    v_mul_f32 v207, v207, v203
    v_cvt_pk_bf16_f32 v207, v207, v207
    v_lshlrev_b32 v207, 16, v207
    v_sub_f32 v208, v208, v202
    v_cvt_pk_bf16_f32 v208, v208, v208
    v_lshlrev_b32 v208, 16, v208
    v_mul_f32 v208, v208, v203
    v_cvt_pk_bf16_f32 v208, v208, v208
    v_lshlrev_b32 v208, 16, v208
    v_sub_f32 v209, v209, v202
    v_cvt_pk_bf16_f32 v209, v209, v209
    v_lshlrev_b32 v209, 16, v209
    v_mul_f32 v209, v209, v203
    v_cvt_pk_bf16_f32 v209, v209, v209
    v_lshlrev_b32 v209, 16, v209
    s_nop 0
L_noownp:
    s_waitcnt lgkmcnt(0)
    s_waitcnt vmcnt(9)
    v_mfma_f32_16x16x32_bf16 v[16:19], a[0:3], v[100:103], 0
    v_mfma_f32_16x16x32_bf16 v[20:23], a[4:7], v[100:103], 0
    v_mfma_f32_16x16x32_bf16 v[24:27], a[8:11], v[100:103], 0
    v_mfma_f32_16x16x32_bf16 v[28:31], a[12:15], v[100:103], 0
    v_mfma_f32_16x16x32_bf16 v[32:35], a[16:19], v[100:103], 0
    buffer_load_dwordx4 v[158:161], v9, s[44:47], s62 offen sc1
    s_add_u32 s62, s62, 1024
    s_waitcnt vmcnt(9)
    v_mfma_f32_16x16x32_bf16 v[16:19], a[20:23], v[104:107], v[16:19]
    v_mfma_f32_16x16x32_bf16 v[20:23], a[24:27], v[104:107], v[20:23]
    v_mfma_f32_16x16x32_bf16 v[24:27], a[28:31], v[104:107], v[24:27]
    v_mfma_f32_16x16x32_bf16 v[28:31], a[32:35], v[104:107], v[28:31]
    v_mfma_f32_16x16x32_bf16 v[32:35], a[36:39], v[104:107], v[32:35]
    buffer_load_dwordx4 v[162:165], v9, s[44:47], s62 offen sc1
    s_add_u32 s62, s62, 1024
    s_waitcnt vmcnt(9)
    v_mfma_f32_16x16x32_bf16 v[16:19], a[40:43], v[108:111], v[16:19]
    v_mfma_f32_16x16x32_bf16 v[20:23], a[44:47], v[108:111], v[20:23]
    v_mfma_f32_16x16x32_bf16 v[24:27], a[48:51], v[108:111], v[24:27]
    v_mfma_f32_16x16x32_bf16 v[28:31], a[52:55], v[108:111], v[28:31]
    v_mfma_f32_16x16x32_bf16 v[32:35], a[56:59], v[108:111], v[32:35]
    buffer_load_dwordx4 v[166:169], v9, s[44:47], s62 offen sc1
    s_add_u32 s62, s62, 1024
    s_waitcnt vmcnt(9)
    v_mfma_f32_16x16x32_bf16 v[16:19], a[60:63], v[112:115], v[16:19]
    v_mfma_f32_16x16x32_bf16 v[20:23], a[64:67], v[112:115], v[20:23]
    v_mfma_f32_16x16x32_bf16 v[24:27], a[68:71], v[112:115], v[24:27]
    v_mfma_f32_16x16x32_bf16 v[28:31], a[72:75], v[112:115], v[28:31]
    v_mfma_f32_16x16x32_bf16 v[32:35], a[76:79], v[112:115], v[32:35]
    buffer_load_dwordx4 v[170:173], v9, s[44:47], s62 offen sc1
    s_add_u32 s62, s62, 1024
    s_waitcnt vmcnt(9)
    v_mfma_f32_16x16x32_bf16 v[16:19], a[80:83], v[116:119], v[16:19]
    v_mfma_f32_16x16x32_bf16 v[20:23], a[84:87], v[116:119], v[20:23]
    v_mfma_f32_16x16x32_bf16 v[24:27], a[88:91], v[116:119], v[24:27]
    v_mfma_f32_16x16x32_bf16 v[28:31], a[92:95], v[116:119], v[28:31]
    v_mfma_f32_16x16x32_bf16 v[32:35], a[96:99], v[116:119], v[32:35]
    buffer_load_dwordx4 v[220:223], v9, s[44:47], s62 offen sc1
    s_add_u32 s62, s62, 1024
    s_waitcnt vmcnt(9)
    v_mfma_f32_16x16x32_bf16 v[16:19], a[100:103], v[120:123], v[16:19]
    v_mfma_f32_16x16x32_bf16 v[20:23], a[104:107], v[120:123], v[20:23]
    v_mfma_f32_16x16x32_bf16 v[24:27], a[108:111], v[120:123], v[24:27]
    v_mfma_f32_16x16x32_bf16 v[28:31], a[112:115], v[120:123], v[28:31]
    v_mfma_f32_16x16x32_bf16 v[32:35], a[116:119], v[120:123], v[32:35]
    buffer_load_dwordx4 v[224:227], v9, s[44:47], s62 offen sc1
    s_add_u32 s62, s62, 1024
    s_waitcnt vmcnt(9)
    v_mfma_f32_16x16x32_bf16 v[16:19], a[120:123], v[124:127], v[16:19]
    v_mfma_f32_16x16x32_bf16 v[20:23], a[124:127], v[124:127], v[20:23]
    v_mfma_f32_16x16x32_bf16 v[24:27], a[128:131], v[124:127], v[24:27]
    v_mfma_f32_16x16x32_bf16 v[28:31], a[132:135], v[124:127], v[28:31]
    v_mfma_f32_16x16x32_bf16 v[32:35], a[136:139], v[124:127], v[32:35]
    buffer_load_dwordx4 v[228:231], v9, s[44:47], s62 offen sc1
    s_add_u32 s62, s62, 1024
    s_waitcnt vmcnt(9)
    v_mfma_f32_16x16x32_bf16 v[16:19], a[140:143], v[146:149], v[16:19]
    v_mfma_f32_16x16x32_bf16 v[20:23], a[144:147], v[146:149], v[20:23]
    v_mfma_f32_16x16x32_bf16 v[24:27], a[148:151], v[146:149], v[24:27]
    v_mfma_f32_16x16x32_bf16 v[28:31], a[152:155], v[146:149], v[28:31]
    v_mfma_f32_16x16x32_bf16 v[32:35], a[156:159], v[146:149], v[32:35]
    buffer_load_dwordx4 v[232:235], v9, s[44:47], s62 offen sc1
    s_add_u32 s62, s62, 1024
    s_waitcnt vmcnt(9)
    v_mfma_f32_16x16x32_bf16 v[16:19], a[160:163], v[150:153], v[16:19]
    v_mfma_f32_16x16x32_bf16 v[20:23], a[164:167], v[150:153], v[20:23]
    v_mfma_f32_16x16x32_bf16 v[24:27], a[168:171], v[150:153], v[24:27]
    v_mfma_f32_16x16x32_bf16 v[28:31], a[172:175], v[150:153], v[28:31]
    v_mfma_f32_16x16x32_bf16 v[32:35], a[176:179], v[150:153], v[32:35]
    buffer_load_dwordx4 v[240:243], v9, s[44:47], s62 offen sc1
    s_add_u32 s62, s62, 1024
    s_waitcnt vmcnt(9)
    v_mfma_f32_16x16x32_bf16 v[16:19], a[180:183], v[154:157], v[16:19]
    v_mfma_f32_16x16x32_bf16 v[20:23], a[184:187], v[154:157], v[20:23]
    v_mfma_f32_16x16x32_bf16 v[24:27], a[188:191], v[154:157], v[24:27]
    v_mfma_f32_16x16x32_bf16 v[28:31], a[192:195], v[154:157], v[28:31]
    v_mfma_f32_16x16x32_bf16 v[32:35], a[196:199], v[154:157], v[32:35]
    buffer_load_dwordx4 v[244:247], v9, s[44:47], s62 offen sc1
    s_add_u32 s62, s62, 1024
    s_waitcnt vmcnt(9)
    v_mfma_f32_16x16x32_bf16 v[16:19], a[200:203], v[158:161], v[16:19]
    v_mfma_f32_16x16x32_bf16 v[20:23], a[204:207], v[158:161], v[20:23]
    v_mfma_f32_16x16x32_bf16 v[24:27], a[208:211], v[158:161], v[24:27]
    v_mfma_f32_16x16x32_bf16 v[28:31], a[212:215], v[158:161], v[28:31]
    v_mfma_f32_16x16x32_bf16 v[32:35], a[216:219], v[158:161], v[32:35]
    s_waitcnt vmcnt(8)
    s_cmp_ge_u32 s80, 64
    s_cbranch_scc1 L_noown1
    s_nop 0
    v_mul_u32_u24 v10, 3277, v1
    v_lshrrev_b32 v10, 16, v10
    v_mul_u32_u24 v11, 20, v10
    v_sub_u32 v11, v1, v11
    v_mul_u32_u24 v214, 2560, v10
    v_lshl_add_u32 v214, v11, 4, v214
    s_mul_i32 s62, s21, 320
    s_mul_i32 s63, s3, 69120
    s_add_u32 s62, s62, s63
    s_add_u32 s79, s62, 5308416
    s_mov_b32 s62, s79
    s_mov_b32 exec_hi, 0x0fffffff
    buffer_load_dwordx4 v[100:103], v214, s[44:47], s62 offen sc1
    s_add_u32 s62, s62, 7680
    buffer_load_dwordx4 v[104:107], v214, s[44:47], s62 offen sc1
    s_add_u32 s62, s62, 7680
    buffer_load_dwordx4 v[108:111], v214, s[44:47], s62 offen sc1
    s_add_u32 s62, s62, 7680
    buffer_load_dwordx4 v[112:115], v214, s[44:47], s62 offen sc1
    s_add_u32 s62, s62, 7680
    buffer_load_dwordx4 v[116:119], v214, s[44:47], s62 offen sc1
    s_add_u32 s62, s62, 7680
    buffer_load_dwordx4 v[120:123], v214, s[44:47], s62 offen sc1
    s_add_u32 s62, s62, 7680
    buffer_load_dwordx4 v[124:127], v214, s[44:47], s62 offen sc1
    s_add_u32 s62, s62, 7680
    buffer_load_dwordx4 v[146:149], v214, s[44:47], s62 offen sc1
    s_add_u32 s62, s62, 7680
    buffer_load_dwordx4 v[150:153], v214, s[44:47], s62 offen sc1
    s_add_u32 s62, s62, 7680
    s_mov_b64 exec, -1
    v_mul_u32_u24 v12, 320, v10
    v_lshl_add_u32 v12, v11, 4, v12
    s_mul_i32 s63, s3, 960
    s_add_u32 s63, s63, 123904
    v_add_u32 v204, s63, v12
    s_nop 0
L_noown1:
    v_mfma_f32_16x16x32_bf16 v[16:19], a[220:223], v[162:165], v[16:19]
    v_mfma_f32_16x16x32_bf16 v[20:23], a[224:227], v[162:165], v[20:23]
    v_mfma_f32_16x16x32_bf16 v[24:27], a[228:231], v[162:165], v[24:27]
    v_mfma_f32_16x16x32_bf16 v[28:31], a[232:235], v[162:165], v[28:31]
    v_mfma_f32_16x16x32_bf16 v[32:35], a[236:239], v[162:165], v[32:35]
    s_waitcnt lgkmcnt(5)
    s_waitcnt vmcnt(7)
    v_mfma_f32_16x16x32_bf16 v[16:19], v[40:43], v[166:169], v[16:19]
    ds_read_b64_tr_b16 v[80:81], v237 offset:20480
    ds_read_b64_tr_b16 v[82:83], v237 offset:23040
    v_mfma_f32_16x16x32_bf16 v[20:23], v[44:47], v[166:169], v[20:23]
    ds_read_b64_tr_b16 v[84:85], v237 offset:20512
    ds_read_b64_tr_b16 v[86:87], v237 offset:23072
    v_mfma_f32_16x16x32_bf16 v[24:27], v[48:51], v[166:169], v[24:27]
    ds_read_b64_tr_b16 v[88:89], v237 offset:20544
    ds_read_b64_tr_b16 v[90:91], v237 offset:23104
    v_mfma_f32_16x16x32_bf16 v[28:31], v[52:55], v[166:169], v[28:31]
    ds_read_b64_tr_b16 v[92:93], v237 offset:20576
    ds_read_b64_tr_b16 v[94:95], v237 offset:23136
    v_mfma_f32_16x16x32_bf16 v[32:35], v[56:59], v[166:169], v[32:35]
    ds_read_b64_tr_b16 v[96:97], v237 offset:20608
    ds_read_b64_tr_b16 v[98:99], v237 offset:23168
    s_waitcnt lgkmcnt(5)
    s_waitcnt vmcnt(6)
    v_mfma_f32_16x16x32_bf16 v[16:19], v[60:63], v[170:173], v[16:19]
    ds_read_b64_tr_b16 v[40:41], v237 offset:25600
    ds_read_b64_tr_b16 v[42:43], v237 offset:28160
    v_mfma_f32_16x16x32_bf16 v[20:23], v[64:67], v[170:173], v[20:23]
    ds_read_b64_tr_b16 v[44:45], v237 offset:25632
    ds_read_b64_tr_b16 v[46:47], v237 offset:28192
    v_mfma_f32_16x16x32_bf16 v[24:27], v[68:71], v[170:173], v[24:27]
    ds_read_b64_tr_b16 v[48:49], v237 offset:25664
    ds_read_b64_tr_b16 v[50:51], v237 offset:28224
    v_mfma_f32_16x16x32_bf16 v[28:31], v[72:75], v[170:173], v[28:31]
    ds_read_b64_tr_b16 v[52:53], v237 offset:25696
    ds_read_b64_tr_b16 v[54:55], v237 offset:28256
    v_mfma_f32_16x16x32_bf16 v[32:35], v[76:79], v[170:173], v[32:35]
    ds_read_b64_tr_b16 v[56:57], v237 offset:25728
    ds_read_b64_tr_b16 v[58:59], v237 offset:28288
    s_waitcnt lgkmcnt(5)
    s_waitcnt vmcnt(5)
    v_mfma_f32_16x16x32_bf16 v[16:19], v[80:83], v[220:223], v[16:19]
    ds_read_b64_tr_b16 v[60:61], v237 offset:30720
    ds_read_b64_tr_b16 v[62:63], v237 offset:33280
    v_mfma_f32_16x16x32_bf16 v[20:23], v[84:87], v[220:223], v[20:23]
    ds_read_b64_tr_b16 v[64:65], v237 offset:30752
    ds_read_b64_tr_b16 v[66:67], v237 offset:33312
    v_mfma_f32_16x16x32_bf16 v[24:27], v[88:91], v[220:223], v[24:27]
    ds_read_b64_tr_b16 v[68:69], v237 offset:30784
    ds_read_b64_tr_b16 v[70:71], v237 offset:33344
    v_mfma_f32_16x16x32_bf16 v[28:31], v[92:95], v[220:223], v[28:31]
    ds_read_b64_tr_b16 v[72:73], v237 offset:30816
    ds_read_b64_tr_b16 v[74:75], v237 offset:33376
    v_mfma_f32_16x16x32_bf16 v[32:35], v[96:99], v[220:223], v[32:35]
    ds_read_b64_tr_b16 v[76:77], v237 offset:30848
    ds_read_b64_tr_b16 v[78:79], v237 offset:33408
    s_waitcnt lgkmcnt(5)
    s_waitcnt vmcnt(4)
    v_mfma_f32_16x16x32_bf16 v[16:19], v[40:43], v[224:227], v[16:19]
    ds_read_b64_tr_b16 v[80:81], v237 offset:35840
    ds_read_b64_tr_b16 v[82:83], v237 offset:38400
    v_mfma_f32_16x16x32_bf16 v[20:23], v[44:47], v[224:227], v[20:23]
    ds_read_b64_tr_b16 v[84:85], v237 offset:35872
    ds_read_b64_tr_b16 v[86:87], v237 offset:38432
    v_mfma_f32_16x16x32_bf16 v[24:27], v[48:51], v[224:227], v[24:27]
    ds_read_b64_tr_b16 v[88:89], v237 offset:35904
    ds_read_b64_tr_b16 v[90:91], v237 offset:38464
    v_mfma_f32_16x16x32_bf16 v[28:31], v[52:55], v[224:227], v[28:31]
    ds_read_b64_tr_b16 v[92:93], v237 offset:35936
    ds_read_b64_tr_b16 v[94:95], v237 offset:38496
    v_mfma_f32_16x16x32_bf16 v[32:35], v[56:59], v[224:227], v[32:35]
    ds_read_b64_tr_b16 v[96:97], v237 offset:35968
    ds_read_b64_tr_b16 v[98:99], v237 offset:38528
    s_waitcnt lgkmcnt(5)
    s_waitcnt vmcnt(0)
    s_cmp_ge_u32 s80, 64
    s_cbranch_scc1 L_noown2
    s_mov_b32 s74, 0
    s_mov_b32 s64, 0x0c0c0400
    s_mov_b32 s65, 0x04000c0c
    v_mov_b32 v215, s64
    v_mov_b32 v216, s65
    s_sub_u32 s66, 0, s82
    s_mov_b32 exec_hi, 0x0fffffff
L_ycheck:
    s_waitcnt vmcnt(0)
    v_mov_b32 v217, 0
    v_perm_b32 v218, v101, v100, v215
    v_perm_b32 v219, v103, v102, v216
    v_add3_u32 v218, v218, v219, s66
    v_or_b32 v217, v217, v218
    v_perm_b32 v218, v105, v104, v215
    v_perm_b32 v219, v107, v106, v216
    v_add3_u32 v218, v218, v219, s66
    v_or_b32 v217, v217, v218
    v_perm_b32 v218, v109, v108, v215
    v_perm_b32 v219, v111, v110, v216
    v_add3_u32 v218, v218, v219, s66
    v_or_b32 v217, v217, v218
    v_perm_b32 v218, v113, v112, v215
    v_perm_b32 v219, v115, v114, v216
    v_add3_u32 v218, v218, v219, s66
    v_or_b32 v217, v217, v218
    v_perm_b32 v218, v117, v116, v215
    v_perm_b32 v219, v119, v118, v216
    v_add3_u32 v218, v218, v219, s66
    v_or_b32 v217, v217, v218
    v_perm_b32 v218, v121, v120, v215
    v_perm_b32 v219, v123, v122, v216
    v_add3_u32 v218, v218, v219, s66
    v_or_b32 v217, v217, v218
    v_perm_b32 v218, v125, v124, v215
    v_perm_b32 v219, v127, v126, v216
    v_add3_u32 v218, v218, v219, s66
    v_or_b32 v217, v217, v218
    v_perm_b32 v218, v147, v146, v215
    v_perm_b32 v219, v149, v148, v216
    v_add3_u32 v218, v218, v219, s66
    v_or_b32 v217, v217, v218
    v_perm_b32 v218, v151, v150, v215
    v_perm_b32 v219, v153, v152, v216
    v_add3_u32 v218, v218, v219, s66
    v_or_b32 v217, v217, v218
    v_cmp_ne_u32 vcc, 0, v217
    s_cbranch_vccz L_yok
    s_add_u32 s74, s74, 1
    s_cmp_gt_u32 s74, 200000
    s_cbranch_scc1 L_yok
    s_mov_b32 s62, s79
    buffer_load_dwordx4 v[100:103], v214, s[44:47], s62 offen sc1
    s_add_u32 s62, s62, 7680
    buffer_load_dwordx4 v[104:107], v214, s[44:47], s62 offen sc1
    s_add_u32 s62, s62, 7680
    buffer_load_dwordx4 v[108:111], v214, s[44:47], s62 offen sc1
    s_add_u32 s62, s62, 7680
    buffer_load_dwordx4 v[112:115], v214, s[44:47], s62 offen sc1
    s_add_u32 s62, s62, 7680
    buffer_load_dwordx4 v[116:119], v214, s[44:47], s62 offen sc1
    s_add_u32 s62, s62, 7680
    buffer_load_dwordx4 v[120:123], v214, s[44:47], s62 offen sc1
    s_add_u32 s62, s62, 7680
    buffer_load_dwordx4 v[124:127], v214, s[44:47], s62 offen sc1
    s_add_u32 s62, s62, 7680
    buffer_load_dwordx4 v[146:149], v214, s[44:47], s62 offen sc1
    s_add_u32 s62, s62, 7680
    buffer_load_dwordx4 v[150:153], v214, s[44:47], s62 offen sc1
    s_add_u32 s62, s62, 7680
    s_branch L_ycheck
L_yok:
    s_mov_b64 exec, -1
    v_pk_add_f32 v[100:101], v[100:101], v[104:105]
    v_pk_add_f32 v[102:103], v[102:103], v[106:107]
    v_pk_add_f32 v[100:101], v[100:101], v[108:109]
    v_pk_add_f32 v[102:103], v[102:103], v[110:111]
    v_pk_add_f32 v[100:101], v[100:101], v[112:113]
    v_pk_add_f32 v[102:103], v[102:103], v[114:115]
    v_pk_add_f32 v[100:101], v[100:101], v[116:117]
    v_pk_add_f32 v[102:103], v[102:103], v[118:119]
    v_pk_add_f32 v[100:101], v[100:101], v[120:121]
    v_pk_add_f32 v[102:103], v[102:103], v[122:123]
    v_pk_add_f32 v[100:101], v[100:101], v[124:125]
    v_pk_add_f32 v[102:103], v[102:103], v[126:127]
    v_pk_add_f32 v[100:101], v[100:101], v[146:147]
    v_pk_add_f32 v[102:103], v[102:103], v[148:149]
    v_pk_add_f32 v[100:101], v[100:101], v[150:151]
    v_pk_add_f32 v[102:103], v[102:103], v[152:153]
    s_mov_b32 exec_hi, 0x0fffffff
    ds_write_b128 v204, v[100:103]
    s_mov_b64 exec, -1
    s_nop 0
L_noown2:
    v_mfma_f32_16x16x32_bf16 v[16:19], v[60:63], v[228:231], v[16:19]
    ds_read_b64_tr_b16 v[40:41], v237 offset:40960
    ds_read_b64_tr_b16 v[42:43], v237 offset:43520
    v_mfma_f32_16x16x32_bf16 v[20:23], v[64:67], v[228:231], v[20:23]
    ds_read_b64_tr_b16 v[44:45], v237 offset:40992
    ds_read_b64_tr_b16 v[46:47], v237 offset:43552
    v_mfma_f32_16x16x32_bf16 v[24:27], v[68:71], v[228:231], v[24:27]
    ds_read_b64_tr_b16 v[48:49], v237 offset:41024
    ds_read_b64_tr_b16 v[50:51], v237 offset:43584
    v_mfma_f32_16x16x32_bf16 v[28:31], v[72:75], v[228:231], v[28:31]
    ds_read_b64_tr_b16 v[52:53], v237 offset:41056
    ds_read_b64_tr_b16 v[54:55], v237 offset:43616
    v_mfma_f32_16x16x32_bf16 v[32:35], v[76:79], v[228:231], v[32:35]
    ds_read_b64_tr_b16 v[56:57], v237 offset:41088
    ds_read_b64_tr_b16 v[58:59], v237 offset:43648
    s_waitcnt lgkmcnt(5)
    v_mfma_f32_16x16x32_bf16 v[16:19], v[80:83], v[232:235], v[16:19]
    ds_read_b64_tr_b16 v[60:61], v237 offset:46080
    ds_read_b64_tr_b16 v[62:63], v237 offset:48640
    v_mfma_f32_16x16x32_bf16 v[20:23], v[84:87], v[232:235], v[20:23]
    ds_read_b64_tr_b16 v[64:65], v237 offset:46112
    ds_read_b64_tr_b16 v[66:67], v237 offset:48672
    v_mfma_f32_16x16x32_bf16 v[24:27], v[88:91], v[232:235], v[24:27]
    ds_read_b64_tr_b16 v[68:69], v237 offset:46144
    ds_read_b64_tr_b16 v[70:71], v237 offset:48704
    v_mfma_f32_16x16x32_bf16 v[28:31], v[92:95], v[232:235], v[28:31]
    ds_read_b64_tr_b16 v[72:73], v237 offset:46176
    ds_read_b64_tr_b16 v[74:75], v237 offset:48736
    v_mfma_f32_16x16x32_bf16 v[32:35], v[96:99], v[232:235], v[32:35]
    ds_read_b64_tr_b16 v[76:77], v237 offset:46208
    ds_read_b64_tr_b16 v[78:79], v237 offset:48768
    s_waitcnt lgkmcnt(10)
    v_mfma_f32_16x16x32_bf16 v[16:19], v[40:43], v[240:243], v[16:19]
    v_mfma_f32_16x16x32_bf16 v[20:23], v[44:47], v[240:243], v[20:23]
    v_mfma_f32_16x16x32_bf16 v[24:27], v[48:51], v[240:243], v[24:27]
    v_mfma_f32_16x16x32_bf16 v[28:31], v[52:55], v[240:243], v[28:31]
    v_mfma_f32_16x16x32_bf16 v[32:35], v[56:59], v[240:243], v[32:35]
    s_waitcnt lgkmcnt(0)
    v_mfma_f32_16x16x32_bf16 v[16:19], v[60:63], v[244:247], v[16:19]
    v_mfma_f32_16x16x32_bf16 v[20:23], v[64:67], v[244:247], v[20:23]
    v_mfma_f32_16x16x32_bf16 v[24:27], v[68:71], v[244:247], v[24:27]
    v_mfma_f32_16x16x32_bf16 v[28:31], v[72:75], v[244:247], v[28:31]
    v_mfma_f32_16x16x32_bf16 v[32:35], v[76:79], v[244:247], v[32:35]
    s_cmp_ge_u32 s80, 64
    s_cbranch_scc1 L_noown3
    s_nop 0
    v_min_u32 v10, 19, v1
    v_lshlrev_b32 v10, 4, v10
    v_add_u32 v10, 123904, v10
    s_waitcnt lgkmcnt(0)
    s_barrier
    ds_read_b128 v[40:43], v10 offset:0
    ds_read_b128 v[44:47], v10 offset:320
    ds_read_b128 v[48:51], v10 offset:640
    ds_read_b128 v[52:55], v10 offset:960
    ds_read_b128 v[56:59], v10 offset:1280
    ds_read_b128 v[60:63], v10 offset:1600
    ds_read_b128 v[64:67], v10 offset:1920
    ds_read_b128 v[68:71], v10 offset:2240
    ds_read_b128 v[72:75], v10 offset:2560
    ds_read_b128 v[76:79], v10 offset:2880
    ds_read_b128 v[80:83], v10 offset:3200
    ds_read_b128 v[84:87], v10 offset:3520
    s_waitcnt lgkmcnt(0)
    v_pk_add_f32 v[40:41], v[40:41], v[44:45]
    v_pk_add_f32 v[42:43], v[42:43], v[46:47]
    v_pk_add_f32 v[40:41], v[40:41], v[48:49]
    v_pk_add_f32 v[42:43], v[42:43], v[50:51]
    v_pk_add_f32 v[40:41], v[40:41], v[52:53]
    v_pk_add_f32 v[42:43], v[42:43], v[54:55]
    v_pk_add_f32 v[40:41], v[40:41], v[56:57]
    v_pk_add_f32 v[42:43], v[42:43], v[58:59]
    v_pk_add_f32 v[40:41], v[40:41], v[60:61]
    v_pk_add_f32 v[42:43], v[42:43], v[62:63]
    v_pk_add_f32 v[40:41], v[40:41], v[64:65]
    v_pk_add_f32 v[42:43], v[42:43], v[66:67]
    v_pk_add_f32 v[40:41], v[40:41], v[68:69]
    v_pk_add_f32 v[42:43], v[42:43], v[70:71]
    v_pk_add_f32 v[40:41], v[40:41], v[72:73]
    v_pk_add_f32 v[42:43], v[42:43], v[74:75]
    v_pk_add_f32 v[40:41], v[40:41], v[76:77]
    v_pk_add_f32 v[42:43], v[42:43], v[78:79]
    v_pk_add_f32 v[40:41], v[40:41], v[80:81]
    v_pk_add_f32 v[42:43], v[42:43], v[82:83]
    v_pk_add_f32 v[40:41], v[40:41], v[84:85]
    v_pk_add_f32 v[42:43], v[42:43], v[86:87]
    v_cvt_pk_bf16_f32 v40, v40, v40
    v_lshlrev_b32 v40, 16, v40
    v_mul_f32 v40, v40, v205
    v_cvt_pk_bf16_f32 v40, v40, v40
    v_lshlrev_b32 v40, 16, v40
    v_add_f32 v40, v40, v206
    v_cvt_pk_bf16_f32 v40, v40, v40
    v_lshlrev_b32 v40, 16, v40
    v_sub_f32 v210, v40, v206
    v_cvt_pk_bf16_f32 v41, v41, v41
    v_lshlrev_b32 v41, 16, v41
    v_mul_f32 v41, v41, v205
    v_cvt_pk_bf16_f32 v41, v41, v41
    v_lshlrev_b32 v41, 16, v41
    v_add_f32 v41, v41, v207
    v_cvt_pk_bf16_f32 v41, v41, v41
    v_lshlrev_b32 v41, 16, v41
    v_sub_f32 v211, v41, v207
    v_cvt_pk_bf16_f32 v42, v42, v42
    v_lshlrev_b32 v42, 16, v42
    v_mul_f32 v42, v42, v205
    v_cvt_pk_bf16_f32 v42, v42, v42
    v_lshlrev_b32 v42, 16, v42
    v_add_f32 v42, v42, v208
    v_cvt_pk_bf16_f32 v42, v42, v42
    v_lshlrev_b32 v42, 16, v42
    v_sub_f32 v212, v42, v208
    v_cvt_pk_bf16_f32 v43, v43, v43
    v_lshlrev_b32 v43, 16, v43
    v_mul_f32 v43, v43, v205
    v_cvt_pk_bf16_f32 v43, v43, v43
    v_lshlrev_b32 v43, 16, v43
    v_add_f32 v43, v43, v209
    v_cvt_pk_bf16_f32 v43, v43, v43
    v_lshlrev_b32 v43, 16, v43
    v_sub_f32 v213, v43, v209
    s_nop 0
L_noown3:
    s_mul_i32 s62, s3, 5376
    s_add_u32 s62, s62, 102400
    v_and_b32 v9, 15, v1
    v_mul_u32_u24 v9, 336, v9
    v_lshrrev_b32 v10, 4, v1
    v_lshl_add_u32 v9, v10, 4, v9
    v_add_u32 v9, s62, v9
    ds_write_b128 v9, v[16:19] offset:0
    ds_write_b128 v9, v[20:23] offset:64
    ds_write_b128 v9, v[24:27] offset:128
    ds_write_b128 v9, v[28:31] offset:192
    ds_write_b128 v9, v[32:35] offset:256
    v_add_u32 v10, s62, v137
    v_add_u32 v11, s62, v138
    v_add_u32 v12, s62, v139
    s_waitcnt lgkmcnt(0)
    s_sub_u32 s66, s83, s12
    s_cmp_ge_u32 s66, 16
    s_cbranch_scc1 L_norow
    s_mul_i32 s66, s66, 336
    s_add_u32 s66, s66, s62
    v_lshl_add_u32 v9, v1, 4, s66
    s_mov_b32 exec_lo, 0xfffff
    s_mov_b32 exec_hi, 0
    ds_read_b128 v[40:43], v9
    s_waitcnt lgkmcnt(0)
    v_pk_add_f32 v[40:41], v[40:41], v[210:211]
    v_pk_add_f32 v[42:43], v[42:43], v[212:213]
    ds_write_b128 v9, v[40:43]
    s_waitcnt lgkmcnt(0)
    s_mov_b64 exec, -1
L_norow:
    ds_read_b128 v[40:43], v10
    ds_read_b128 v[44:47], v10 offset:16
    ds_read_b128 v[48:51], v11
    ds_read_b128 v[52:55], v11 offset:16
    ds_read_b128 v[56:59], v12
    ds_read_b128 v[60:63], v12 offset:16
    s_waitcnt lgkmcnt(4)
    v_pk_add_f32 v[40:41], v[40:41], v[176:177]
    v_pk_add_f32 v[42:43], v[42:43], v[178:179]
    v_pk_add_f32 v[44:45], v[44:45], v[180:181]
    v_pk_add_f32 v[46:47], v[46:47], v[182:183]
    v_cvt_pk_bf16_f32 v64, v40, v41
    v_cvt_pk_bf16_f32 v65, v42, v43
    v_cvt_pk_bf16_f32 v66, v44, v45
    v_cvt_pk_bf16_f32 v67, v46, v47
    buffer_store_dwordx4 v[64:67], v134, s[36:39], s85 offen
    s_waitcnt lgkmcnt(2)
    v_pk_add_f32 v[48:49], v[48:49], v[184:185]
    v_pk_add_f32 v[50:51], v[50:51], v[186:187]
    v_pk_add_f32 v[52:53], v[52:53], v[188:189]
    v_pk_add_f32 v[54:55], v[54:55], v[190:191]
    v_cvt_pk_bf16_f32 v68, v48, v49
    v_cvt_pk_bf16_f32 v69, v50, v51
    v_cvt_pk_bf16_f32 v70, v52, v53
    v_cvt_pk_bf16_f32 v71, v54, v55
    buffer_store_dwordx4 v[68:71], v135, s[36:39], s85 offen
    s_waitcnt lgkmcnt(0)
    v_pk_add_f32 v[56:57], v[56:57], v[192:193]
    v_pk_add_f32 v[58:59], v[58:59], v[194:195]
    v_pk_add_f32 v[60:61], v[60:61], v[196:197]
    v_pk_add_f32 v[62:63], v[62:63], v[198:199]
    v_cvt_pk_bf16_f32 v72, v56, v57
    v_cvt_pk_bf16_f32 v73, v58, v59
    v_cvt_pk_bf16_f32 v74, v60, v61
    v_cvt_pk_bf16_f32 v75, v62, v63
    s_mov_b32 exec_hi, 0
    buffer_store_dwordx4 v[72:75], v136, s[36:39], s85 offen
    s_mov_b64 exec, -1
L_exit:
    s_endpgm
L_code_end:
.section .rodata,"a"
.p2align 6
.amdhsa_kernel parallel_sum__linear_kernel_hedgehog__moe_arch_mod__prompt_kernel
  .amdhsa_next_free_vgpr 512
  .amdhsa_next_free_sgpr 102
  .amdhsa_accum_offset 256
  .amdhsa_group_segment_fixed_size 0
  .amdhsa_kernarg_size 96
  .amdhsa_user_sgpr_count 2
  .amdhsa_user_sgpr_kernarg_segment_ptr 1
  .amdhsa_system_sgpr_workgroup_id_x 1
  .amdhsa_float_denorm_mode_32 3
.end_amdhsa_kernel
```
